```python
import torch

def _softmax(x, axis=-1):
    return torch.softmax(x, dim=axis)
def _gelu(x):
    return torch.nn.functional.gelu(x, approximate="tanh")
def _silu(x):
    return torch.nn.functional.silu(x)
def _sigmoid(x):
    return torch.sigmoid(x)
def _layernorm(x, axis=-1, eps=1e-5):
    m = x.mean(dim=axis, keepdim=True)
    v = x.var(dim=axis, keepdim=True, unbiased=False)
    return (x - m) / torch.sqrt(v + eps)
def _scatter_add(tgt, idx, src, axis=0):
    return tgt.clone().index_add_(axis, idx, src)
def _segment_sum(src, seg, n):
    out = torch.zeros((n,) + src.shape[1:], dtype=src.dtype)
    return out.index_add_(0, seg, src)
def _pad(x, pw):
    flat = tuple(v for pair in reversed(pw) for v in pair)
    return torch.nn.functional.pad(x, flat)

kernel_name = 'parallel_sum__grouped_kv_mqa__glu_gated_geglu__prompt'

def setup_inputs():

    _w = (lambda a: (lambda t: t.to(torch.bfloat16) if t.is_floating_point() else t)(torch.as_tensor(a)))
    def _A_setup():
        B, S, D, H = 1, 2048, 448, 16
        Dh = D // H
        return {
            "x": _w((lambda *s: torch.randn(*s, dtype=torch.bfloat16) * 0.05)(B, S, D)),
            "wq": _w((lambda *s: torch.randn(*s, dtype=torch.bfloat16) * 0.05)(D, H * Dh)),
            "wk": _w((lambda *s: torch.randn(*s, dtype=torch.bfloat16) * 0.05)(D, Dh)),
            "wv": _w((lambda *s: torch.randn(*s, dtype=torch.bfloat16) * 0.05)(D, Dh)),
            "wo": _w((lambda *s: torch.randn(*s, dtype=torch.bfloat16) * 0.05)(H * Dh, D)),
        }
    _A_in = _A_setup()

    def _B_setup():
        B, S, Dm, Df = 1, 2048, 448, 1792
        return {
            "x": _w((lambda *s: torch.randn(*s, dtype=torch.bfloat16) * 0.05)(B, S, Dm)),
            "w_gate": _w((lambda *s: torch.randn(*s, dtype=torch.bfloat16) * 0.4)(Dm, Df) * (Dm ** -0.5)),
            "w_up": _w((lambda *s: torch.randn(*s, dtype=torch.bfloat16) * 0.4)(Dm, Df) * (Dm ** -0.5)),
            "w_down": _w((lambda *s: torch.randn(*s, dtype=torch.bfloat16) * 0.4)(Df, Dm) * (Df ** -0.5)),
        }
    _B_in = _B_setup()

    return {
        "A_x": _A_in["x"],
        "A_wq": _A_in["wq"],
        "A_wk": _A_in["wk"],
        "A_wv": _A_in["wv"],
        "A_wo": _A_in["wo"],
        "B_x": _B_in["x"],
        "B_w_gate": _B_in["w_gate"],
        "B_w_up": _B_in["w_up"],
        "B_w_down": _B_in["w_down"],
    }

def reference(A_x, A_wq, A_wk, A_wv, A_wo, B_x, B_w_gate, B_w_up, B_w_down):
    def _A_ref(x, wq, wk, wv, wo):
        B, S, D = x.shape
        H = 16
        Dh = D // H
        q = (lambda x, *d: x.permute(*d))((x @ wq).reshape(B, S, H, Dh), 0, 2, 1, 3)
        k = x @ wk
        v = x @ wv
        scores = torch.einsum("bhqd,bkd->bhqk", q, k) * (Dh ** -0.5)
        p = _softmax(scores, axis=-1)
        o = torch.einsum("bhqk,bkd->bhqd", p, v)
        return (lambda x, *d: x.permute(*d))(o, 0, 2, 1, 3).reshape(B, S, H * Dh) @ wo

    def _B_ref(x, w_gate, w_up, w_down):
        g = torch.einsum("bsd,df->bsf", x, w_gate)
        u = torch.einsum("bsd,df->bsf", x, w_up)
        h = _gelu(g) * u
        return torch.einsum("bsf,fd->bsd", h, w_down)

    x = A_x
    xn = _layernorm(x, axis=-1)
    return x + _A_ref(xn, A_wq, A_wk, A_wv, A_wo) + _B_ref(xn, B_w_gate, B_w_up, B_w_down)
```

```asm
; @launch grid=(256,1,1) block=(512,1,1) lds=163840
.amdgcn_target "amdgcn-amd-amdhsa--gfx950"
.text
.globl parallel_sum__grouped_kv_mqa__glu_gated_geglu__prompt_kernel
.p2align 8
.type parallel_sum__grouped_kv_mqa__glu_gated_geglu__prompt_kernel,@function
parallel_sum__grouped_kv_mqa__glu_gated_geglu__prompt_kernel:
    s_cmp_ge_u32 s2, 256
    s_cbranch_scc1 L_end
    s_load_dwordx16 s[64:79], s[0:1], 0
    s_load_dwordx8 s[80:87], s[0:1], 64
    v_lshrrev_b32 v1, 6, v0
    v_and_b32 v255, 63, v0
    s_and_b32 s44, s2, 7
    s_lshr_b32 s45, s2, 3
    v_readfirstlane_b32 s42, v1
    s_getpc_b64 s[48:49]
L_pc:
    s_cmp_lt_u32 s42, 4
    s_cbranch_scc1 L_nopf
    s_sub_u32 s48, s48, L_pc-parallel_sum__grouped_kv_mqa__glu_gated_geglu__prompt_kernel
    s_subb_u32 s49, s49, 0
    v_lshlrev_b32 v2, 4, v0
    v_add_u32 v2, -4096, v2
    global_load_dwordx4 v[4:7], v2, s[48:49]
    s_and_b32 s46, s45, 15
    s_lshl_b32 s46, s46, 12
    v_add_u32 v14, s46, v2
    v_min_u32 v14, L_end-parallel_sum__grouped_kv_mqa__glu_gated_geglu__prompt_kernel-16, v14
    global_load_dwordx4 v[4:7], v14, s[48:49]
L_nopf:
    s_lshr_b32 s40, s44, 1
    s_mul_i32 s40, s40, 4
    s_lshr_b32 s46, s45, 3
    s_add_u32 s40, s40, s46
    s_and_b32 s41, s44, 1
    s_lshl_b32 s41, s41, 3
    s_and_b32 s46, s45, 7
    s_add_u32 s41, s41, s46
    s_and_b32 s43, s42, 3
    s_lshr_b32 s46, s41, 3
    s_sub_u32 s100, s41, s46
    s_and_b32 s101, s41, 7
    s_mul_i32 s95, s40, 4
    s_add_u32 s95, s95, s41
    s_mul_i32 s46, s95, 37
    s_lshr_b32 s46, s46, 8
    s_mul_i32 s46, s46, 7
    s_sub_u32 s95, s95, s46
    v_lshrrev_b32 v122, 3, v255
    v_mul_u32_u24 v122, 896, v122
    v_and_b32 v123, 7, v255
    v_lshrrev_b32 v124, 4, v255
    v_xor_b32 v123, v123, v124
    v_lshl_add_u32 v112, v123, 4, v122
    v_xor_b32 v123, 4, v123
    v_lshl_add_u32 v113, v123, 4, v122
    s_lshl_b32 s90, s40, 2
    s_add_u32 s90, s90, s43
    s_mul_i32 s90, s90, 28672
    s_mul_i32 s91, s43, 28672
    s_lshl_b32 s46, s95, 7
    s_add_u32 s90, s90, s46
    s_mov_b32 s92, s95
    s_waitcnt lgkmcnt(0)
    s_mov_b32 s8, s64
    s_mov_b32 s9, s65
    s_mov_b32 s10, 1835008
    s_mov_b32 s11, 0x20000
    s_cmp_ge_u32 s42, 4
    s_cbranch_scc1 L_B
    s_add_u32 m0, s91, 12288
    s_add_u32 s46, s90, 0
    buffer_load_dwordx4 v112, s[8:11], s46 offen lds
    s_add_u32 m0, s91, 13312
    s_add_u32 s46, s90, 7168
    buffer_load_dwordx4 v113, s[8:11], s46 offen lds
    s_add_u32 m0, s91, 14336
    s_add_u32 s46, s90, 14336
    buffer_load_dwordx4 v112, s[8:11], s46 offen lds
    s_add_u32 m0, s91, 15360
    s_add_u32 s46, s90, 21504
    buffer_load_dwordx4 v113, s[8:11], s46 offen lds
    s_add_u32 s92, s92, 1
    s_add_u32 s90, s90, 128
    s_cmp_eq_u32 s92, 7
    s_cselect_b32 s92, 0, s92
    s_cselect_b32 s46, 896, 0
    s_sub_u32 s90, s90, s46
    s_add_u32 m0, s91, 16384
    s_add_u32 s46, s90, 0
    buffer_load_dwordx4 v112, s[8:11], s46 offen lds
    s_add_u32 m0, s91, 17408
    s_add_u32 s46, s90, 7168
    buffer_load_dwordx4 v113, s[8:11], s46 offen lds
    s_add_u32 m0, s91, 18432
    s_add_u32 s46, s90, 14336
    buffer_load_dwordx4 v112, s[8:11], s46 offen lds
    s_add_u32 m0, s91, 19456
    s_add_u32 s46, s90, 21504
    buffer_load_dwordx4 v113, s[8:11], s46 offen lds
    s_add_u32 s92, s92, 1
    s_add_u32 s90, s90, 128
    s_cmp_eq_u32 s92, 7
    s_cselect_b32 s92, 0, s92
    s_cselect_b32 s46, 896, 0
    s_sub_u32 s90, s90, s46
    s_mov_b32 s20, s86
    s_mov_b32 s21, s87
    s_mov_b32 s22, 16777216
    s_mov_b32 s23, 0x20000
    v_and_b32 v122, 31, v255
    v_lshrrev_b32 v123, 5, v255
    v_bfe_u32 v124, v122, 1, 3
    v_xor_b32 v123, v123, v124
    v_lshlrev_b32 v123, 4, v123
    v_lshrrev_b32 v124, 3, v122
    v_lshl_add_u32 v123, v124, 10, v123
    v_and_b32 v124, 7, v122
    v_lshl_add_u32 v123, v124, 7, v123
    v_add_u32 v114, s91, v123
    v_xor_b32 v115, 32, v114
    v_xor_b32 v116, 64, v114
    v_xor_b32 v117, 0x60, v114
    v_mov_b32 v118, 0
    v_mov_b32 v119, 0
    v_mov_b32 v120, 0
    v_mov_b32 v121, 0
    v_lshrrev_b32 v124, 5, v255
    v_bfe_u32 v125, v255, 2, 2
    v_bfe_u32 v126, v255, 1, 1
    v_lshlrev_b32 v240, 10, v124
    v_lshl_add_u32 v240, v125, 7, v240
    v_lshl_add_u32 v240, v126, 11, v240
    v_xor_b32 v127, v125, v126
    v_lshl_add_u32 v240, v127, 5, v240
    v_bfe_u32 v127, v255, 4, 1
    v_lshl_add_u32 v240, v127, 4, v240
    v_and_b32 v126, 1, v255
    v_lshl_add_u32 v240, v126, 3, v240
    v_add_u32 v240, 98304, v240
    v_xor_b32 v241, 32, v240
    v_xor_b32 v242, 64, v240
    v_xor_b32 v243, 0x60, v240
    v_lshlrev_b32 v248, 9, v124
    v_lshl_add_u32 v248, v125, 6, v248
    v_lshl_add_u32 v248, v127, 5, v248
    v_and_b32 v126, 3, v255
    v_lshl_add_u32 v248, v126, 3, v248
    v_add_u32 v248, 98304, v248
    v_lshlrev_b32 v244, 4, v255
    v_and_b32 v232, 1, v255
    v_lshlrev_b32 v232, 4, v232
    v_mov_b32 v233, 0x3f80
    v_lshlrev_b32 v232, v232, v233
    v_bfe_u32 v233, v255, 2, 1
    v_lshrrev_b32 v234, 5, v255
    v_cmp_eq_u32 vcc, v233, v234
    v_bfe_u32 v233, v255, 3, 1
    v_bfe_u32 v234, v255, 1, 1
    v_cndmask_b32 v232, 0, v232, vcc
    v_lshl_add_u32 v233, v233, 1, v234
    v_bfe_u32 v234, v255, 4, 1
    v_lshl_add_u32 v233, v234, 2, v233
    v_cmp_eq_u32 vcc, 0, v233
    v_cmp_eq_u32 s[44:45], 1, v233
    s_nop 0
    v_cndmask_b32 v224, 0, v232, vcc
    v_cndmask_b32 v225, 0, v232, s[44:45]
    v_cmp_eq_u32 vcc, 2, v233
    v_cmp_eq_u32 s[44:45], 3, v233
    s_nop 0
    v_cndmask_b32 v226, 0, v232, vcc
    v_cndmask_b32 v227, 0, v232, s[44:45]
    v_cmp_eq_u32 vcc, 4, v233
    v_cmp_eq_u32 s[44:45], 5, v233
    s_nop 0
    v_cndmask_b32 v228, 0, v232, vcc
    v_cndmask_b32 v229, 0, v232, s[44:45]
    v_cmp_eq_u32 vcc, 6, v233
    v_cmp_eq_u32 s[44:45], 7, v233
    s_nop 0
    v_cndmask_b32 v230, 0, v232, vcc
    v_cndmask_b32 v231, 0, v232, s[44:45]
    s_mov_b32 s47, 0x3f803f80
    s_add_u32 m0, s91, 20480
    s_add_u32 s46, s90, 0
    buffer_load_dwordx4 v112, s[8:11], s46 offen lds
    s_add_u32 m0, s91, 21504
    s_add_u32 s46, s90, 7168
    buffer_load_dwordx4 v113, s[8:11], s46 offen lds
    s_add_u32 m0, s91, 22528
    s_add_u32 s46, s90, 14336
    buffer_load_dwordx4 v112, s[8:11], s46 offen lds
    s_add_u32 m0, s91, 23552
    s_add_u32 s46, s90, 21504
    buffer_load_dwordx4 v113, s[8:11], s46 offen lds
    s_add_u32 s92, s92, 1
    s_add_u32 s90, s90, 128
    s_cmp_eq_u32 s92, 7
    s_cselect_b32 s92, 0, s92
    s_cselect_b32 s46, 896, 0
    s_sub_u32 s90, s90, s46
    s_waitcnt vmcnt(8)
    ds_read_b128 v[0:3], v114 offset:12288
    ds_read_b128 v[4:7], v115 offset:12288
    ds_read_b128 v[8:11], v116 offset:12288
    ds_read_b128 v[12:15], v117 offset:12288
    s_add_u32 m0, s91, 24576
    s_add_u32 s46, s90, 0
    buffer_load_dwordx4 v112, s[8:11], s46 offen lds
    s_add_u32 m0, s91, 25600
    s_add_u32 s46, s90, 7168
    buffer_load_dwordx4 v113, s[8:11], s46 offen lds
    s_add_u32 m0, s91, 26624
    s_add_u32 s46, s90, 14336
    buffer_load_dwordx4 v112, s[8:11], s46 offen lds
    s_add_u32 m0, s91, 27648
    s_add_u32 s46, s90, 21504
    buffer_load_dwordx4 v113, s[8:11], s46 offen lds
    s_add_u32 s92, s92, 1
    s_add_u32 s90, s90, 128
    s_cmp_eq_u32 s92, 7
    s_cselect_b32 s92, 0, s92
    s_cselect_b32 s46, 896, 0
    s_sub_u32 s90, s90, s46
    s_waitcnt vmcnt(8)
    ds_read_b128 v[16:19], v114 offset:16384
    ds_read_b128 v[20:23], v115 offset:16384
    ds_read_b128 v[24:27], v116 offset:16384
    ds_read_b128 v[28:31], v117 offset:16384
    s_waitcnt lgkmcnt(4)
    v_dot2_f32_bf16 v118, v0, s47, v118
    v_dot2_f32_bf16 v120, v0, v0, v120
    v_dot2_f32_bf16 v119, v1, s47, v119
    v_dot2_f32_bf16 v121, v1, v1, v121
    v_dot2_f32_bf16 v118, v2, s47, v118
    v_dot2_f32_bf16 v120, v2, v2, v120
    v_dot2_f32_bf16 v119, v3, s47, v119
    v_dot2_f32_bf16 v121, v3, v3, v121
    v_dot2_f32_bf16 v118, v4, s47, v118
    v_dot2_f32_bf16 v120, v4, v4, v120
    v_dot2_f32_bf16 v119, v5, s47, v119
    v_dot2_f32_bf16 v121, v5, v5, v121
    v_dot2_f32_bf16 v118, v6, s47, v118
    v_dot2_f32_bf16 v120, v6, v6, v120
    v_dot2_f32_bf16 v119, v7, s47, v119
    v_dot2_f32_bf16 v121, v7, v7, v121
    v_dot2_f32_bf16 v118, v8, s47, v118
    v_dot2_f32_bf16 v120, v8, v8, v120
    v_dot2_f32_bf16 v119, v9, s47, v119
    v_dot2_f32_bf16 v121, v9, v9, v121
    v_dot2_f32_bf16 v118, v10, s47, v118
    v_dot2_f32_bf16 v120, v10, v10, v120
    v_dot2_f32_bf16 v119, v11, s47, v119
    v_dot2_f32_bf16 v121, v11, v11, v121
    v_dot2_f32_bf16 v118, v12, s47, v118
    v_dot2_f32_bf16 v120, v12, v12, v120
    v_dot2_f32_bf16 v119, v13, s47, v119
    v_dot2_f32_bf16 v121, v13, v13, v121
    v_dot2_f32_bf16 v118, v14, s47, v118
    v_dot2_f32_bf16 v120, v14, v14, v120
    v_dot2_f32_bf16 v119, v15, s47, v119
    v_dot2_f32_bf16 v121, v15, v15, v121
    s_add_u32 m0, s91, 0
    s_add_u32 s46, s90, 0
    buffer_load_dwordx4 v112, s[8:11], s46 offen lds
    s_add_u32 m0, s91, 1024
    s_add_u32 s46, s90, 7168
    buffer_load_dwordx4 v113, s[8:11], s46 offen lds
    s_add_u32 m0, s91, 2048
    s_add_u32 s46, s90, 14336
    buffer_load_dwordx4 v112, s[8:11], s46 offen lds
    s_add_u32 m0, s91, 3072
    s_add_u32 s46, s90, 21504
    buffer_load_dwordx4 v113, s[8:11], s46 offen lds
    s_add_u32 s92, s92, 1
    s_add_u32 s90, s90, 128
    s_cmp_eq_u32 s92, 7
    s_cselect_b32 s92, 0, s92
    s_cselect_b32 s46, 896, 0
    s_sub_u32 s90, s90, s46
    s_waitcnt vmcnt(8)
    ds_read_b128 v[32:35], v114 offset:20480
    ds_read_b128 v[36:39], v115 offset:20480
    ds_read_b128 v[40:43], v116 offset:20480
    ds_read_b128 v[44:47], v117 offset:20480
    s_waitcnt lgkmcnt(4)
    v_dot2_f32_bf16 v118, v16, s47, v118
    v_dot2_f32_bf16 v120, v16, v16, v120
    v_dot2_f32_bf16 v119, v17, s47, v119
    v_dot2_f32_bf16 v121, v17, v17, v121
    v_dot2_f32_bf16 v118, v18, s47, v118
    v_dot2_f32_bf16 v120, v18, v18, v120
    v_dot2_f32_bf16 v119, v19, s47, v119
    v_dot2_f32_bf16 v121, v19, v19, v121
    v_dot2_f32_bf16 v118, v20, s47, v118
    v_dot2_f32_bf16 v120, v20, v20, v120
    v_dot2_f32_bf16 v119, v21, s47, v119
    v_dot2_f32_bf16 v121, v21, v21, v121
    v_dot2_f32_bf16 v118, v22, s47, v118
    v_dot2_f32_bf16 v120, v22, v22, v120
    v_dot2_f32_bf16 v119, v23, s47, v119
    v_dot2_f32_bf16 v121, v23, v23, v121
    v_dot2_f32_bf16 v118, v24, s47, v118
    v_dot2_f32_bf16 v120, v24, v24, v120
    v_dot2_f32_bf16 v119, v25, s47, v119
    v_dot2_f32_bf16 v121, v25, v25, v121
    v_dot2_f32_bf16 v118, v26, s47, v118
    v_dot2_f32_bf16 v120, v26, v26, v120
    v_dot2_f32_bf16 v119, v27, s47, v119
    v_dot2_f32_bf16 v121, v27, v27, v121
    v_dot2_f32_bf16 v118, v28, s47, v118
    v_dot2_f32_bf16 v120, v28, v28, v120
    v_dot2_f32_bf16 v119, v29, s47, v119
    v_dot2_f32_bf16 v121, v29, v29, v121
    v_dot2_f32_bf16 v118, v30, s47, v118
    v_dot2_f32_bf16 v120, v30, v30, v120
    v_dot2_f32_bf16 v119, v31, s47, v119
    v_dot2_f32_bf16 v121, v31, v31, v121
    s_add_u32 m0, s91, 4096
    s_add_u32 s46, s90, 0
    buffer_load_dwordx4 v112, s[8:11], s46 offen lds
    s_add_u32 m0, s91, 5120
    s_add_u32 s46, s90, 7168
    buffer_load_dwordx4 v113, s[8:11], s46 offen lds
    s_add_u32 m0, s91, 6144
    s_add_u32 s46, s90, 14336
    buffer_load_dwordx4 v112, s[8:11], s46 offen lds
    s_add_u32 m0, s91, 7168
    s_add_u32 s46, s90, 21504
    buffer_load_dwordx4 v113, s[8:11], s46 offen lds
    s_add_u32 s92, s92, 1
    s_add_u32 s90, s90, 128
    s_cmp_eq_u32 s92, 7
    s_cselect_b32 s92, 0, s92
    s_cselect_b32 s46, 896, 0
    s_sub_u32 s90, s90, s46
    s_waitcnt vmcnt(8)
    ds_read_b128 v[48:51], v114 offset:24576
    ds_read_b128 v[52:55], v115 offset:24576
    ds_read_b128 v[56:59], v116 offset:24576
    ds_read_b128 v[60:63], v117 offset:24576
    s_waitcnt lgkmcnt(4)
    v_dot2_f32_bf16 v118, v32, s47, v118
    v_dot2_f32_bf16 v120, v32, v32, v120
    v_dot2_f32_bf16 v119, v33, s47, v119
    v_dot2_f32_bf16 v121, v33, v33, v121
    v_dot2_f32_bf16 v118, v34, s47, v118
    v_dot2_f32_bf16 v120, v34, v34, v120
    v_dot2_f32_bf16 v119, v35, s47, v119
    v_dot2_f32_bf16 v121, v35, v35, v121
    v_dot2_f32_bf16 v118, v36, s47, v118
    v_dot2_f32_bf16 v120, v36, v36, v120
    v_dot2_f32_bf16 v119, v37, s47, v119
    v_dot2_f32_bf16 v121, v37, v37, v121
    v_dot2_f32_bf16 v118, v38, s47, v118
    v_dot2_f32_bf16 v120, v38, v38, v120
    v_dot2_f32_bf16 v119, v39, s47, v119
    v_dot2_f32_bf16 v121, v39, v39, v121
    v_dot2_f32_bf16 v118, v40, s47, v118
    v_dot2_f32_bf16 v120, v40, v40, v120
    v_dot2_f32_bf16 v119, v41, s47, v119
    v_dot2_f32_bf16 v121, v41, v41, v121
    v_dot2_f32_bf16 v118, v42, s47, v118
    v_dot2_f32_bf16 v120, v42, v42, v120
    v_dot2_f32_bf16 v119, v43, s47, v119
    v_dot2_f32_bf16 v121, v43, v43, v121
    v_dot2_f32_bf16 v118, v44, s47, v118
    v_dot2_f32_bf16 v120, v44, v44, v120
    v_dot2_f32_bf16 v119, v45, s47, v119
    v_dot2_f32_bf16 v121, v45, v45, v121
    v_dot2_f32_bf16 v118, v46, s47, v118
    v_dot2_f32_bf16 v120, v46, v46, v120
    v_dot2_f32_bf16 v119, v47, s47, v119
    v_dot2_f32_bf16 v121, v47, v47, v121
    s_add_u32 m0, s91, 8192
    s_add_u32 s46, s90, 0
    buffer_load_dwordx4 v112, s[8:11], s46 offen lds
    s_add_u32 m0, s91, 9216
    s_add_u32 s46, s90, 7168
    buffer_load_dwordx4 v113, s[8:11], s46 offen lds
    s_add_u32 m0, s91, 10240
    s_add_u32 s46, s90, 14336
    buffer_load_dwordx4 v112, s[8:11], s46 offen lds
    s_add_u32 m0, s91, 11264
    s_add_u32 s46, s90, 21504
    buffer_load_dwordx4 v113, s[8:11], s46 offen lds
    s_barrier
    s_waitcnt vmcnt(8)
    ds_read_b128 v[64:67], v114 offset:0
    ds_read_b128 v[68:71], v115 offset:0
    ds_read_b128 v[72:75], v116 offset:0
    ds_read_b128 v[76:79], v117 offset:0
    s_waitcnt lgkmcnt(4)
    v_dot2_f32_bf16 v118, v48, s47, v118
    v_dot2_f32_bf16 v120, v48, v48, v120
    v_dot2_f32_bf16 v119, v49, s47, v119
    v_dot2_f32_bf16 v121, v49, v49, v121
    v_dot2_f32_bf16 v118, v50, s47, v118
    v_dot2_f32_bf16 v120, v50, v50, v120
    v_dot2_f32_bf16 v119, v51, s47, v119
    v_dot2_f32_bf16 v121, v51, v51, v121
    v_dot2_f32_bf16 v118, v52, s47, v118
    v_dot2_f32_bf16 v120, v52, v52, v120
    v_dot2_f32_bf16 v119, v53, s47, v119
    v_dot2_f32_bf16 v121, v53, v53, v121
    v_dot2_f32_bf16 v118, v54, s47, v118
    v_dot2_f32_bf16 v120, v54, v54, v120
    v_dot2_f32_bf16 v119, v55, s47, v119
    v_dot2_f32_bf16 v121, v55, v55, v121
    v_dot2_f32_bf16 v118, v56, s47, v118
    v_dot2_f32_bf16 v120, v56, v56, v120
    v_dot2_f32_bf16 v119, v57, s47, v119
    v_dot2_f32_bf16 v121, v57, v57, v121
    v_dot2_f32_bf16 v118, v58, s47, v118
    v_dot2_f32_bf16 v120, v58, v58, v120
    v_dot2_f32_bf16 v119, v59, s47, v119
    v_dot2_f32_bf16 v121, v59, v59, v121
    v_dot2_f32_bf16 v118, v60, s47, v118
    v_dot2_f32_bf16 v120, v60, v60, v120
    v_dot2_f32_bf16 v119, v61, s47, v119
    v_dot2_f32_bf16 v121, v61, v61, v121
    v_dot2_f32_bf16 v118, v62, s47, v118
    v_dot2_f32_bf16 v120, v62, v62, v120
    v_dot2_f32_bf16 v119, v63, s47, v119
    v_dot2_f32_bf16 v121, v63, v63, v121
    s_waitcnt vmcnt(4)
    ds_read_b128 v[80:83], v114 offset:4096
    ds_read_b128 v[84:87], v115 offset:4096
    ds_read_b128 v[88:91], v116 offset:4096
    ds_read_b128 v[92:95], v117 offset:4096
    s_waitcnt lgkmcnt(4)
    v_dot2_f32_bf16 v118, v64, s47, v118
    v_dot2_f32_bf16 v120, v64, v64, v120
    v_dot2_f32_bf16 v119, v65, s47, v119
    v_dot2_f32_bf16 v121, v65, v65, v121
    v_dot2_f32_bf16 v118, v66, s47, v118
    v_dot2_f32_bf16 v120, v66, v66, v120
    v_dot2_f32_bf16 v119, v67, s47, v119
    v_dot2_f32_bf16 v121, v67, v67, v121
    v_dot2_f32_bf16 v118, v68, s47, v118
    v_dot2_f32_bf16 v120, v68, v68, v120
    v_dot2_f32_bf16 v119, v69, s47, v119
    v_dot2_f32_bf16 v121, v69, v69, v121
    v_dot2_f32_bf16 v118, v70, s47, v118
    v_dot2_f32_bf16 v120, v70, v70, v120
    v_dot2_f32_bf16 v119, v71, s47, v119
    v_dot2_f32_bf16 v121, v71, v71, v121
    v_dot2_f32_bf16 v118, v72, s47, v118
    v_dot2_f32_bf16 v120, v72, v72, v120
    v_dot2_f32_bf16 v119, v73, s47, v119
    v_dot2_f32_bf16 v121, v73, v73, v121
    v_dot2_f32_bf16 v118, v74, s47, v118
    v_dot2_f32_bf16 v120, v74, v74, v120
    v_dot2_f32_bf16 v119, v75, s47, v119
    v_dot2_f32_bf16 v121, v75, v75, v121
    v_dot2_f32_bf16 v118, v76, s47, v118
    v_dot2_f32_bf16 v120, v76, v76, v120
    v_dot2_f32_bf16 v119, v77, s47, v119
    v_dot2_f32_bf16 v121, v77, v77, v121
    v_dot2_f32_bf16 v118, v78, s47, v118
    v_dot2_f32_bf16 v120, v78, v78, v120
    v_dot2_f32_bf16 v119, v79, s47, v119
    v_dot2_f32_bf16 v121, v79, v79, v121
    s_waitcnt vmcnt(0)
    ds_read_b128 v[96:99], v114 offset:8192
    ds_read_b128 v[100:103], v115 offset:8192
    ds_read_b128 v[104:107], v116 offset:8192
    ds_read_b128 v[108:111], v117 offset:8192
    s_waitcnt lgkmcnt(4)
    v_dot2_f32_bf16 v118, v80, s47, v118
    v_dot2_f32_bf16 v120, v80, v80, v120
    v_dot2_f32_bf16 v119, v81, s47, v119
    v_dot2_f32_bf16 v121, v81, v81, v121
    v_dot2_f32_bf16 v118, v82, s47, v118
    v_dot2_f32_bf16 v120, v82, v82, v120
    v_dot2_f32_bf16 v119, v83, s47, v119
    v_dot2_f32_bf16 v121, v83, v83, v121
    v_dot2_f32_bf16 v118, v84, s47, v118
    v_dot2_f32_bf16 v120, v84, v84, v120
    v_dot2_f32_bf16 v119, v85, s47, v119
    v_dot2_f32_bf16 v121, v85, v85, v121
    v_dot2_f32_bf16 v118, v86, s47, v118
    v_dot2_f32_bf16 v120, v86, v86, v120
    v_dot2_f32_bf16 v119, v87, s47, v119
    v_dot2_f32_bf16 v121, v87, v87, v121
    v_dot2_f32_bf16 v118, v88, s47, v118
    v_dot2_f32_bf16 v120, v88, v88, v120
    v_dot2_f32_bf16 v119, v89, s47, v119
    v_dot2_f32_bf16 v121, v89, v89, v121
    v_dot2_f32_bf16 v118, v90, s47, v118
    v_dot2_f32_bf16 v120, v90, v90, v120
    v_dot2_f32_bf16 v119, v91, s47, v119
    v_dot2_f32_bf16 v121, v91, v91, v121
    v_dot2_f32_bf16 v118, v92, s47, v118
    v_dot2_f32_bf16 v120, v92, v92, v120
    v_dot2_f32_bf16 v119, v93, s47, v119
    v_dot2_f32_bf16 v121, v93, v93, v121
    v_dot2_f32_bf16 v118, v94, s47, v118
    v_dot2_f32_bf16 v120, v94, v94, v120
    v_dot2_f32_bf16 v119, v95, s47, v119
    v_dot2_f32_bf16 v121, v95, v95, v121
    s_waitcnt lgkmcnt(0)
    v_dot2_f32_bf16 v118, v96, s47, v118
    v_dot2_f32_bf16 v120, v96, v96, v120
    v_dot2_f32_bf16 v119, v97, s47, v119
    v_dot2_f32_bf16 v121, v97, v97, v121
    v_dot2_f32_bf16 v118, v98, s47, v118
    v_dot2_f32_bf16 v120, v98, v98, v120
    v_dot2_f32_bf16 v119, v99, s47, v119
    v_dot2_f32_bf16 v121, v99, v99, v121
    v_dot2_f32_bf16 v118, v100, s47, v118
    v_dot2_f32_bf16 v120, v100, v100, v120
    v_dot2_f32_bf16 v119, v101, s47, v119
    v_dot2_f32_bf16 v121, v101, v101, v121
    v_dot2_f32_bf16 v118, v102, s47, v118
    v_dot2_f32_bf16 v120, v102, v102, v120
    v_dot2_f32_bf16 v119, v103, s47, v119
    v_dot2_f32_bf16 v121, v103, v103, v121
    v_dot2_f32_bf16 v118, v104, s47, v118
    v_dot2_f32_bf16 v120, v104, v104, v120
    v_dot2_f32_bf16 v119, v105, s47, v119
    v_dot2_f32_bf16 v121, v105, v105, v121
    v_dot2_f32_bf16 v118, v106, s47, v118
    v_dot2_f32_bf16 v120, v106, v106, v120
    v_dot2_f32_bf16 v119, v107, s47, v119
    v_dot2_f32_bf16 v121, v107, v107, v121
    v_dot2_f32_bf16 v118, v108, s47, v118
    v_dot2_f32_bf16 v120, v108, v108, v120
    v_dot2_f32_bf16 v119, v109, s47, v119
    v_dot2_f32_bf16 v121, v109, v109, v121
    v_dot2_f32_bf16 v118, v110, s47, v118
    v_dot2_f32_bf16 v120, v110, v110, v120
    v_dot2_f32_bf16 v119, v111, s47, v119
    v_dot2_f32_bf16 v121, v111, v111, v121
    s_nop 1
    v_add_f32 v118, v118, v119
    v_add_f32 v120, v120, v121
    v_mov_b32 v119, v118
    v_mov_b32 v121, v120
    s_mov_b32 s48, 0xffff0000
    s_lshl_b32 s49, s43, 11
    v_permlane32_swap_b32 v118, v119
    v_permlane32_swap_b32 v120, v121
    s_add_u32 s49, s49, 57344
    v_add_f32 v118, v118, v119
    v_add_f32 v120, v120, v121
    v_mul_f32 v252, 0x3b124925, v118
    v_mul_f32 v120, 0x3b124925, v120
    v_fma_f32 v120, -v252, v252, v120
    v_max_f32 v120, 0, v120
    v_cvt_pk_bf16_f32 v252, v252, v252
    v_and_b32 v252, s48, v252
    v_mov_b32 v247, v120
    s_cmp_eq_u32 s101, 7
    s_cbranch_scc1 L_AS
    v_sub_f32 v160, 0, v252
    v_mov_b32 v161, v160
    v_mov_b32 v162, v160
    v_mov_b32 v163, v160
    v_mov_b32 v164, v160
    v_mov_b32 v165, v160
    v_mov_b32 v166, v160
    v_mov_b32 v167, v160
    v_mov_b32 v168, v160
    v_mov_b32 v169, v160
    v_mov_b32 v170, v160
    v_mov_b32 v171, v160
    v_mov_b32 v172, v160
    v_mov_b32 v173, v160
    v_mov_b32 v174, v160
    v_mov_b32 v175, v160
    s_nop 1
    v_mfma_f32_32x32x16_bf16 v[176:191], v[224:227], v[0:3], v[160:175]
    v_cvt_pk_bf16_f32 v247, v247, v247
    v_and_b32 v247, s48, v247
    v_add_f32 v247, 0x3727c5ac, v247
    v_cvt_pk_bf16_f32 v247, v247, v247
    v_and_b32 v247, s48, v247
    v_mfma_f32_32x32x16_bf16 v[176:191], v[228:231], v[4:7], v[176:191]
    v_sqrt_f32 v247, v247
    s_nop 0
    v_cvt_pk_bf16_f32 v247, v247, v247
    v_and_b32 v247, s48, v247
    v_rcp_f32 v253, v247
    v_mfma_f32_32x32x16_bf16 v[192:207], v[224:227], v[8:11], v[160:175]
    v_mul_f32 v247, v247, v247
    v_mul_f32 v249, 0x3e8b97f6, v253
    v_mul_f32 v245, 0xc0135761, v253
    v_mul_f32 v246, v253, v253
    v_mul_f32 v246, v246, v245
    v_mfma_f32_32x32x16_bf16 v[192:207], v[228:231], v[12:15], v[192:207]
    v_mul_f32 v246, 0x3d372713, v246
    v_mfma_f32_32x32x16_bf16 v[208:223], v[224:227], v[16:19], v[160:175]
    v_cvt_pk_bf16_f32 v0, v176, v177
    v_cvt_pk_bf16_f32 v1, v178, v179
    v_cvt_pk_bf16_f32 v2, v180, v181
    v_cvt_pk_bf16_f32 v3, v182, v183
    v_mfma_f32_32x32x16_bf16 v[208:223], v[228:231], v[20:23], v[208:223]
    v_cvt_pk_bf16_f32 v4, v184, v185
    v_cvt_pk_bf16_f32 v5, v186, v187
    v_cvt_pk_bf16_f32 v6, v188, v189
    v_cvt_pk_bf16_f32 v7, v190, v191
    v_mfma_f32_32x32x16_bf16 v[176:191], v[224:227], v[24:27], v[160:175]
    v_cvt_pk_bf16_f32 v8, v192, v193
    v_cvt_pk_bf16_f32 v9, v194, v195
    v_cvt_pk_bf16_f32 v10, v196, v197
    v_cvt_pk_bf16_f32 v11, v198, v199
    v_mfma_f32_32x32x16_bf16 v[176:191], v[228:231], v[28:31], v[176:191]
    v_cvt_pk_bf16_f32 v12, v200, v201
    v_cvt_pk_bf16_f32 v13, v202, v203
    v_cvt_pk_bf16_f32 v14, v204, v205
    v_cvt_pk_bf16_f32 v15, v206, v207
    v_mfma_f32_32x32x16_bf16 v[192:207], v[224:227], v[32:35], v[160:175]
    v_cvt_pk_bf16_f32 v16, v208, v209
    v_cvt_pk_bf16_f32 v17, v210, v211
    v_cvt_pk_bf16_f32 v18, v212, v213
    v_cvt_pk_bf16_f32 v19, v214, v215
    v_mfma_f32_32x32x16_bf16 v[192:207], v[228:231], v[36:39], v[192:207]
    v_cvt_pk_bf16_f32 v20, v216, v217
    v_cvt_pk_bf16_f32 v21, v218, v219
    v_cvt_pk_bf16_f32 v22, v220, v221
    v_cvt_pk_bf16_f32 v23, v222, v223
    v_mfma_f32_32x32x16_bf16 v[208:223], v[224:227], v[40:43], v[160:175]
    v_cvt_pk_bf16_f32 v24, v176, v177
    v_cvt_pk_bf16_f32 v25, v178, v179
    v_cvt_pk_bf16_f32 v26, v180, v181
    v_cvt_pk_bf16_f32 v27, v182, v183
    v_mfma_f32_32x32x16_bf16 v[208:223], v[228:231], v[44:47], v[208:223]
    v_cvt_pk_bf16_f32 v28, v184, v185
    v_cvt_pk_bf16_f32 v29, v186, v187
    v_cvt_pk_bf16_f32 v30, v188, v189
    v_cvt_pk_bf16_f32 v31, v190, v191
    v_mfma_f32_32x32x16_bf16 v[176:191], v[224:227], v[48:51], v[160:175]
    v_cvt_pk_bf16_f32 v32, v192, v193
    v_cvt_pk_bf16_f32 v33, v194, v195
    v_cvt_pk_bf16_f32 v34, v196, v197
    v_cvt_pk_bf16_f32 v35, v198, v199
    v_mfma_f32_32x32x16_bf16 v[176:191], v[228:231], v[52:55], v[176:191]
    v_cvt_pk_bf16_f32 v36, v200, v201
    v_cvt_pk_bf16_f32 v37, v202, v203
    v_cvt_pk_bf16_f32 v38, v204, v205
    v_cvt_pk_bf16_f32 v39, v206, v207
    v_mfma_f32_32x32x16_bf16 v[192:207], v[224:227], v[56:59], v[160:175]
    v_cvt_pk_bf16_f32 v40, v208, v209
    v_cvt_pk_bf16_f32 v41, v210, v211
    v_cvt_pk_bf16_f32 v42, v212, v213
    v_cvt_pk_bf16_f32 v43, v214, v215
    v_mfma_f32_32x32x16_bf16 v[192:207], v[228:231], v[60:63], v[192:207]
    v_cvt_pk_bf16_f32 v44, v216, v217
    v_cvt_pk_bf16_f32 v45, v218, v219
    v_cvt_pk_bf16_f32 v46, v220, v221
    v_cvt_pk_bf16_f32 v47, v222, v223
    v_mfma_f32_32x32x16_bf16 v[208:223], v[224:227], v[64:67], v[160:175]
    v_cvt_pk_bf16_f32 v48, v176, v177
    v_cvt_pk_bf16_f32 v49, v178, v179
    v_cvt_pk_bf16_f32 v50, v180, v181
    v_cvt_pk_bf16_f32 v51, v182, v183
    v_mfma_f32_32x32x16_bf16 v[208:223], v[228:231], v[68:71], v[208:223]
    v_cvt_pk_bf16_f32 v52, v184, v185
    v_cvt_pk_bf16_f32 v53, v186, v187
    v_cvt_pk_bf16_f32 v54, v188, v189
    v_cvt_pk_bf16_f32 v55, v190, v191
    v_mfma_f32_32x32x16_bf16 v[176:191], v[224:227], v[72:75], v[160:175]
    v_cvt_pk_bf16_f32 v56, v192, v193
    v_cvt_pk_bf16_f32 v57, v194, v195
    v_cvt_pk_bf16_f32 v58, v196, v197
    v_cvt_pk_bf16_f32 v59, v198, v199
    v_mfma_f32_32x32x16_bf16 v[176:191], v[228:231], v[76:79], v[176:191]
    v_cvt_pk_bf16_f32 v60, v200, v201
    v_cvt_pk_bf16_f32 v61, v202, v203
    v_cvt_pk_bf16_f32 v62, v204, v205
    v_cvt_pk_bf16_f32 v63, v206, v207
    v_mfma_f32_32x32x16_bf16 v[192:207], v[224:227], v[80:83], v[160:175]
    v_cvt_pk_bf16_f32 v64, v208, v209
    v_cvt_pk_bf16_f32 v65, v210, v211
    v_cvt_pk_bf16_f32 v66, v212, v213
    v_cvt_pk_bf16_f32 v67, v214, v215
    v_mfma_f32_32x32x16_bf16 v[192:207], v[228:231], v[84:87], v[192:207]
    v_cvt_pk_bf16_f32 v68, v216, v217
    v_cvt_pk_bf16_f32 v69, v218, v219
    v_cvt_pk_bf16_f32 v70, v220, v221
    v_cvt_pk_bf16_f32 v71, v222, v223
    v_mfma_f32_32x32x16_bf16 v[208:223], v[224:227], v[88:91], v[160:175]
    v_cvt_pk_bf16_f32 v72, v176, v177
    v_cvt_pk_bf16_f32 v73, v178, v179
    v_cvt_pk_bf16_f32 v74, v180, v181
    v_cvt_pk_bf16_f32 v75, v182, v183
    v_mfma_f32_32x32x16_bf16 v[208:223], v[228:231], v[92:95], v[208:223]
    v_cvt_pk_bf16_f32 v76, v184, v185
    v_cvt_pk_bf16_f32 v77, v186, v187
    v_cvt_pk_bf16_f32 v78, v188, v189
    v_cvt_pk_bf16_f32 v79, v190, v191
    v_mfma_f32_32x32x16_bf16 v[176:191], v[224:227], v[96:99], v[160:175]
    v_cvt_pk_bf16_f32 v80, v192, v193
    v_cvt_pk_bf16_f32 v81, v194, v195
    v_cvt_pk_bf16_f32 v82, v196, v197
    v_cvt_pk_bf16_f32 v83, v198, v199
    v_mfma_f32_32x32x16_bf16 v[176:191], v[228:231], v[100:103], v[176:191]
    v_cvt_pk_bf16_f32 v84, v200, v201
    v_cvt_pk_bf16_f32 v85, v202, v203
    v_cvt_pk_bf16_f32 v86, v204, v205
    v_cvt_pk_bf16_f32 v87, v206, v207
    v_mfma_f32_32x32x16_bf16 v[192:207], v[224:227], v[104:107], v[160:175]
    v_cvt_pk_bf16_f32 v88, v208, v209
    v_cvt_pk_bf16_f32 v89, v210, v211
    v_cvt_pk_bf16_f32 v90, v212, v213
    v_cvt_pk_bf16_f32 v91, v214, v215
    v_mfma_f32_32x32x16_bf16 v[192:207], v[228:231], v[108:111], v[192:207]
    v_cvt_pk_bf16_f32 v92, v216, v217
    v_cvt_pk_bf16_f32 v93, v218, v219
    v_cvt_pk_bf16_f32 v94, v220, v221
    v_cvt_pk_bf16_f32 v95, v222, v223
    v_cvt_pk_bf16_f32 v96, v176, v177
    v_cvt_pk_bf16_f32 v97, v178, v179
    v_cvt_pk_bf16_f32 v98, v180, v181
    v_cvt_pk_bf16_f32 v99, v182, v183
    v_cvt_pk_bf16_f32 v100, v184, v185
    v_cvt_pk_bf16_f32 v101, v186, v187
    v_cvt_pk_bf16_f32 v102, v188, v189
    v_cvt_pk_bf16_f32 v103, v190, v191
    v_cvt_pk_bf16_f32 v104, v192, v193
    v_cvt_pk_bf16_f32 v105, v194, v195
    v_cvt_pk_bf16_f32 v106, v196, v197
    v_cvt_pk_bf16_f32 v107, v198, v199
    v_cvt_pk_bf16_f32 v108, v200, v201
    v_cvt_pk_bf16_f32 v109, v202, v203
    v_cvt_pk_bf16_f32 v110, v204, v205
    v_cvt_pk_bf16_f32 v111, v206, v207
    s_barrier
    ds_read_b64_tr_b16 v[224:225], v248 offset:16384
    ds_read_b64_tr_b16 v[226:227], v248 offset:16640
    ds_read_b64_tr_b16 v[228:229], v240 offset:20480
    ds_read_b64_tr_b16 v[230:231], v240 offset:20992
    ds_read_b64_tr_b16 v[232:233], v241 offset:20480
    ds_read_b64_tr_b16 v[234:235], v241 offset:20992
    ds_read_b64_tr_b16 v[236:237], v242 offset:20480
    ds_read_b64_tr_b16 v[238:239], v242 offset:20992
    ds_read_b64_tr_b16 v[208:209], v243 offset:20480
    ds_read_b64_tr_b16 v[210:211], v243 offset:20992
    ds_read_b64_tr_b16 v[212:213], v248 offset:17408
    ds_read_b64_tr_b16 v[214:215], v248 offset:17664
    s_waitcnt lgkmcnt(10)
    v_mfma_f32_32x32x16_bf16 v[144:159], v[224:227], v[0:3], 0
    s_waitcnt lgkmcnt(8)
    ds_read_b64_tr_b16 v[224:225], v240 offset:24576
    ds_read_b64_tr_b16 v[226:227], v240 offset:25088
    s_lshl_b32 s50, s40, 2
    s_add_u32 s50, s50, s43
    s_mul_i32 s50, s50, 112
    s_lshl_b32 s51, s100, 3
    v_mfma_f32_32x32x16_bf16 v[112:127], v[228:231], v[0:3], 0
    s_waitcnt lgkmcnt(8)
    ds_read_b64_tr_b16 v[228:229], v241 offset:24576
    ds_read_b64_tr_b16 v[230:231], v241 offset:25088
    s_add_u32 s50, s50, s51
    s_lshl_b32 s50, s50, 10
    s_add_u32 s50, s50, 1048576
    s_add_u32 s51, s50, 4096
    v_mfma_f32_32x32x16_bf16 v[128:143], v[232:235], v[0:3], 0
    s_waitcnt lgkmcnt(8)
    ds_read_b64_tr_b16 v[232:233], v242 offset:24576
    ds_read_b64_tr_b16 v[234:235], v242 offset:25088
    v_mfma_f32_32x32x16_bf16 v[160:175], v[236:239], v[0:3], 0
    s_waitcnt lgkmcnt(8)
    ds_read_b64_tr_b16 v[236:237], v243 offset:24576
    ds_read_b64_tr_b16 v[238:239], v243 offset:25088
    v_mfma_f32_32x32x16_bf16 v[176:191], v[208:211], v[0:3], 0
    s_waitcnt lgkmcnt(8)
    ds_read_b64_tr_b16 v[208:209], v248 offset:18432
    ds_read_b64_tr_b16 v[210:211], v248 offset:18688
    v_mfma_f32_32x32x16_bf16 v[144:159], v[212:215], v[4:7], v[144:159]
    s_waitcnt lgkmcnt(8)
    ds_read_b64_tr_b16 v[212:213], v240 offset:28672
    ds_read_b64_tr_b16 v[214:215], v240 offset:29184
    v_mfma_f32_32x32x16_bf16 v[112:127], v[224:227], v[4:7], v[112:127]
    s_waitcnt lgkmcnt(8)
    ds_read_b64_tr_b16 v[224:225], v241 offset:28672
    ds_read_b64_tr_b16 v[226:227], v241 offset:29184
    v_mfma_f32_32x32x16_bf16 v[128:143], v[228:231], v[4:7], v[128:143]
    s_waitcnt lgkmcnt(8)
    ds_read_b64_tr_b16 v[228:229], v242 offset:28672
    ds_read_b64_tr_b16 v[230:231], v242 offset:29184
    v_mfma_f32_32x32x16_bf16 v[160:175], v[232:235], v[4:7], v[160:175]
    s_waitcnt lgkmcnt(8)
    ds_read_b64_tr_b16 v[232:233], v243 offset:28672
    ds_read_b64_tr_b16 v[234:235], v243 offset:29184
    v_mfma_f32_32x32x16_bf16 v[176:191], v[236:239], v[4:7], v[176:191]
    s_waitcnt lgkmcnt(8)
    ds_read_b64_tr_b16 v[236:237], v248 offset:19456
    ds_read_b64_tr_b16 v[238:239], v248 offset:19712
    v_mfma_f32_32x32x16_bf16 v[144:159], v[208:211], v[8:11], v[144:159]
    s_waitcnt lgkmcnt(8)
    ds_read_b64_tr_b16 v[208:209], v240 offset:32768
    ds_read_b64_tr_b16 v[210:211], v240 offset:33280
    v_mfma_f32_32x32x16_bf16 v[112:127], v[212:215], v[8:11], v[112:127]
    s_waitcnt lgkmcnt(8)
    ds_read_b64_tr_b16 v[212:213], v241 offset:32768
    ds_read_b64_tr_b16 v[214:215], v241 offset:33280
    v_mfma_f32_32x32x16_bf16 v[128:143], v[224:227], v[8:11], v[128:143]
    s_waitcnt lgkmcnt(8)
    ds_read_b64_tr_b16 v[224:225], v242 offset:32768
    ds_read_b64_tr_b16 v[226:227], v242 offset:33280
    v_mfma_f32_32x32x16_bf16 v[160:175], v[228:231], v[8:11], v[160:175]
    s_waitcnt lgkmcnt(8)
    ds_read_b64_tr_b16 v[228:229], v243 offset:32768
    ds_read_b64_tr_b16 v[230:231], v243 offset:33280
    v_mfma_f32_32x32x16_bf16 v[176:191], v[232:235], v[8:11], v[176:191]
    s_waitcnt lgkmcnt(8)
    s_barrier
    ds_read_b64_tr_b16 v[232:233], v248 offset:36864
    ds_read_b64_tr_b16 v[234:235], v248 offset:37120
    v_mfma_f32_32x32x16_bf16 v[144:159], v[236:239], v[12:15], v[144:159]
    s_waitcnt lgkmcnt(8)
    ds_read_b64_tr_b16 v[236:237], v240 offset:40960
    ds_read_b64_tr_b16 v[238:239], v240 offset:41472
    v_mfma_f32_32x32x16_bf16 v[112:127], v[208:211], v[12:15], v[112:127]
    s_waitcnt lgkmcnt(8)
    ds_read_b64_tr_b16 v[208:209], v241 offset:40960
    ds_read_b64_tr_b16 v[210:211], v241 offset:41472
    v_mfma_f32_32x32x16_bf16 v[128:143], v[212:215], v[12:15], v[128:143]
    s_waitcnt lgkmcnt(8)
    ds_read_b64_tr_b16 v[212:213], v242 offset:40960
    ds_read_b64_tr_b16 v[214:215], v242 offset:41472
    v_mfma_f32_32x32x16_bf16 v[160:175], v[224:227], v[12:15], v[160:175]
    s_waitcnt lgkmcnt(8)
    ds_read_b64_tr_b16 v[224:225], v243 offset:40960
    ds_read_b64_tr_b16 v[226:227], v243 offset:41472
    v_mfma_f32_32x32x16_bf16 v[176:191], v[228:231], v[12:15], v[176:191]
    s_waitcnt lgkmcnt(8)
    ds_read_b64_tr_b16 v[228:229], v248 offset:37888
    ds_read_b64_tr_b16 v[230:231], v248 offset:38144
    v_mfma_f32_32x32x16_bf16 v[144:159], v[232:235], v[16:19], v[144:159]
    s_waitcnt lgkmcnt(8)
    ds_read_b64_tr_b16 v[232:233], v240 offset:45056
    ds_read_b64_tr_b16 v[234:235], v240 offset:45568
    v_mfma_f32_32x32x16_bf16 v[112:127], v[236:239], v[16:19], v[112:127]
    s_waitcnt lgkmcnt(8)
    ds_read_b64_tr_b16 v[236:237], v241 offset:45056
    ds_read_b64_tr_b16 v[238:239], v241 offset:45568
    v_mfma_f32_32x32x16_bf16 v[128:143], v[208:211], v[16:19], v[128:143]
    s_waitcnt lgkmcnt(8)
    ds_read_b64_tr_b16 v[208:209], v242 offset:45056
    ds_read_b64_tr_b16 v[210:211], v242 offset:45568
    v_mfma_f32_32x32x16_bf16 v[160:175], v[212:215], v[16:19], v[160:175]
    s_waitcnt lgkmcnt(8)
    ds_read_b64_tr_b16 v[212:213], v243 offset:45056
    ds_read_b64_tr_b16 v[214:215], v243 offset:45568
    v_mfma_f32_32x32x16_bf16 v[176:191], v[224:227], v[16:19], v[176:191]
    s_waitcnt lgkmcnt(8)
    ds_read_b64_tr_b16 v[224:225], v248 offset:38912
    ds_read_b64_tr_b16 v[226:227], v248 offset:39168
    v_mfma_f32_32x32x16_bf16 v[144:159], v[228:231], v[20:23], v[144:159]
    s_waitcnt lgkmcnt(8)
    ds_read_b64_tr_b16 v[228:229], v240 offset:49152
    ds_read_b64_tr_b16 v[230:231], v240 offset:49664
    v_mfma_f32_32x32x16_bf16 v[112:127], v[232:235], v[20:23], v[112:127]
    s_waitcnt lgkmcnt(8)
    ds_read_b64_tr_b16 v[232:233], v241 offset:49152
    ds_read_b64_tr_b16 v[234:235], v241 offset:49664
    v_mfma_f32_32x32x16_bf16 v[128:143], v[236:239], v[20:23], v[128:143]
    s_waitcnt lgkmcnt(8)
    ds_read_b64_tr_b16 v[236:237], v242 offset:49152
    ds_read_b64_tr_b16 v[238:239], v242 offset:49664
    v_mfma_f32_32x32x16_bf16 v[160:175], v[208:211], v[20:23], v[160:175]
    s_waitcnt lgkmcnt(8)
    ds_read_b64_tr_b16 v[208:209], v243 offset:49152
    ds_read_b64_tr_b16 v[210:211], v243 offset:49664
    v_mfma_f32_32x32x16_bf16 v[176:191], v[212:215], v[20:23], v[176:191]
    s_waitcnt lgkmcnt(8)
    s_barrier
    ds_read_b64_tr_b16 v[212:213], v248 offset:39936
    ds_read_b64_tr_b16 v[214:215], v248 offset:40192
    v_mfma_f32_32x32x16_bf16 v[144:159], v[224:227], v[24:27], v[144:159]
    s_waitcnt lgkmcnt(8)
    ds_read_b64_tr_b16 v[224:225], v240 offset:53248
    ds_read_b64_tr_b16 v[226:227], v240 offset:53760
    v_mfma_f32_32x32x16_bf16 v[112:127], v[228:231], v[24:27], v[112:127]
    s_waitcnt lgkmcnt(8)
    ds_read_b64_tr_b16 v[228:229], v241 offset:53248
    ds_read_b64_tr_b16 v[230:231], v241 offset:53760
    v_mfma_f32_32x32x16_bf16 v[128:143], v[232:235], v[24:27], v[128:143]
    s_waitcnt lgkmcnt(8)
    ds_read_b64_tr_b16 v[232:233], v242 offset:53248
    ds_read_b64_tr_b16 v[234:235], v242 offset:53760
    v_mfma_f32_32x32x16_bf16 v[160:175], v[236:239], v[24:27], v[160:175]
    s_waitcnt lgkmcnt(8)
    ds_read_b64_tr_b16 v[236:237], v243 offset:53248
    ds_read_b64_tr_b16 v[238:239], v243 offset:53760
    v_mfma_f32_32x32x16_bf16 v[176:191], v[208:211], v[24:27], v[176:191]
    s_waitcnt lgkmcnt(8)
    ds_read_b64_tr_b16 v[208:209], v248 offset:57344
    ds_read_b64_tr_b16 v[210:211], v248 offset:57600
    v_mfma_f32_32x32x16_bf16 v[144:159], v[212:215], v[28:31], v[144:159]
    s_waitcnt lgkmcnt(8)
    ds_read_b64_tr_b16 v[212:213], v240 offset:61440
    ds_read_b64_tr_b16 v[214:215], v240 offset:61952
    v_mfma_f32_32x32x16_bf16 v[112:127], v[224:227], v[28:31], v[112:127]
    s_waitcnt lgkmcnt(8)
    ds_read_b64_tr_b16 v[224:225], v241 offset:61440
    ds_read_b64_tr_b16 v[226:227], v241 offset:61952
    v_mfma_f32_32x32x16_bf16 v[128:143], v[228:231], v[28:31], v[128:143]
    s_waitcnt lgkmcnt(8)
    ds_read_b64_tr_b16 v[228:229], v242 offset:61440
    ds_read_b64_tr_b16 v[230:231], v242 offset:61952
    v_mfma_f32_32x32x16_bf16 v[160:175], v[232:235], v[28:31], v[160:175]
    s_waitcnt lgkmcnt(8)
    ds_read_b64_tr_b16 v[232:233], v243 offset:61440
    ds_read_b64_tr_b16 v[234:235], v243 offset:61952
    v_mfma_f32_32x32x16_bf16 v[176:191], v[236:239], v[28:31], v[176:191]
    s_waitcnt lgkmcnt(8)
    ds_read_b64_tr_b16 v[236:237], v248 offset:58368
    ds_read_b64_tr_b16 v[238:239], v248 offset:58624
    v_add_u32 v240, -32768, v240
    v_mfma_f32_32x32x16_bf16 v[144:159], v[208:211], v[32:35], v[144:159]
    s_waitcnt lgkmcnt(8)
    ds_read_b64_tr_b16 v[208:209], v240 offset:0
    ds_read_b64_tr_b16 v[210:211], v240 offset:512
    v_add_u32 v241, -32768, v241
    v_mfma_f32_32x32x16_bf16 v[112:127], v[212:215], v[32:35], v[112:127]
    s_waitcnt lgkmcnt(8)
    ds_read_b64_tr_b16 v[212:213], v241 offset:0
    ds_read_b64_tr_b16 v[214:215], v241 offset:512
    v_add_u32 v242, -32768, v242
    v_mfma_f32_32x32x16_bf16 v[128:143], v[224:227], v[32:35], v[128:143]
    s_waitcnt lgkmcnt(8)
    ds_read_b64_tr_b16 v[224:225], v242 offset:0
    ds_read_b64_tr_b16 v[226:227], v242 offset:512
    v_add_u32 v243, -32768, v243
    v_mfma_f32_32x32x16_bf16 v[160:175], v[228:231], v[32:35], v[160:175]
    s_waitcnt lgkmcnt(8)
    ds_read_b64_tr_b16 v[228:229], v243 offset:0
    ds_read_b64_tr_b16 v[230:231], v243 offset:512
    v_mfma_f32_32x32x16_bf16 v[176:191], v[232:235], v[32:35], v[176:191]
    s_waitcnt lgkmcnt(8)
    s_barrier
    ds_read_b64_tr_b16 v[232:233], v248 offset:59392
    ds_read_b64_tr_b16 v[234:235], v248 offset:59648
    v_mfma_f32_32x32x16_bf16 v[144:159], v[236:239], v[36:39], v[144:159]
    s_waitcnt lgkmcnt(8)
    ds_read_b64_tr_b16 v[236:237], v240 offset:4096
    ds_read_b64_tr_b16 v[238:239], v240 offset:4608
    v_mfma_f32_32x32x16_bf16 v[112:127], v[208:211], v[36:39], v[112:127]
    s_waitcnt lgkmcnt(8)
    ds_read_b64_tr_b16 v[208:209], v241 offset:4096
    ds_read_b64_tr_b16 v[210:211], v241 offset:4608
    v_mfma_f32_32x32x16_bf16 v[128:143], v[212:215], v[36:39], v[128:143]
    s_waitcnt lgkmcnt(8)
    ds_read_b64_tr_b16 v[212:213], v242 offset:4096
    ds_read_b64_tr_b16 v[214:215], v242 offset:4608
    v_mfma_f32_32x32x16_bf16 v[160:175], v[224:227], v[36:39], v[160:175]
    s_waitcnt lgkmcnt(8)
    ds_read_b64_tr_b16 v[224:225], v243 offset:4096
    ds_read_b64_tr_b16 v[226:227], v243 offset:4608
    v_mfma_f32_32x32x16_bf16 v[176:191], v[228:231], v[36:39], v[176:191]
    s_waitcnt lgkmcnt(8)
    ds_read_b64_tr_b16 v[228:229], v248 offset:60416
    ds_read_b64_tr_b16 v[230:231], v248 offset:60672
    v_mfma_f32_32x32x16_bf16 v[144:159], v[232:235], v[40:43], v[144:159]
    s_waitcnt lgkmcnt(8)
    ds_read_b64_tr_b16 v[232:233], v240 offset:8192
    ds_read_b64_tr_b16 v[234:235], v240 offset:8704
    v_mfma_f32_32x32x16_bf16 v[112:127], v[236:239], v[40:43], v[112:127]
    s_waitcnt lgkmcnt(8)
    ds_read_b64_tr_b16 v[236:237], v241 offset:8192
    ds_read_b64_tr_b16 v[238:239], v241 offset:8704
    v_mfma_f32_32x32x16_bf16 v[128:143], v[208:211], v[40:43], v[128:143]
    s_waitcnt lgkmcnt(8)
    ds_read_b64_tr_b16 v[208:209], v242 offset:8192
    ds_read_b64_tr_b16 v[210:211], v242 offset:8704
    v_mfma_f32_32x32x16_bf16 v[160:175], v[212:215], v[40:43], v[160:175]
    s_waitcnt lgkmcnt(8)
    ds_read_b64_tr_b16 v[212:213], v243 offset:8192
    ds_read_b64_tr_b16 v[214:215], v243 offset:8704
    v_add_u32 v248, -32768, v248
    v_mfma_f32_32x32x16_bf16 v[176:191], v[224:227], v[40:43], v[176:191]
    s_waitcnt lgkmcnt(8)
    ds_read_b64_tr_b16 v[224:225], v248 offset:12288
    ds_read_b64_tr_b16 v[226:227], v248 offset:12544
    v_mfma_f32_32x32x16_bf16 v[144:159], v[228:231], v[44:47], v[144:159]
    s_waitcnt lgkmcnt(8)
    ds_read_b64_tr_b16 v[228:229], v240 offset:16384
    ds_read_b64_tr_b16 v[230:231], v240 offset:16896
    v_mfma_f32_32x32x16_bf16 v[112:127], v[232:235], v[44:47], v[112:127]
    s_waitcnt lgkmcnt(8)
    ds_read_b64_tr_b16 v[232:233], v241 offset:16384
    ds_read_b64_tr_b16 v[234:235], v241 offset:16896
    v_mfma_f32_32x32x16_bf16 v[128:143], v[236:239], v[44:47], v[128:143]
    s_waitcnt lgkmcnt(8)
    ds_read_b64_tr_b16 v[236:237], v242 offset:16384
    ds_read_b64_tr_b16 v[238:239], v242 offset:16896
    v_mfma_f32_32x32x16_bf16 v[160:175], v[208:211], v[44:47], v[160:175]
    s_waitcnt lgkmcnt(8)
    ds_read_b64_tr_b16 v[208:209], v243 offset:16384
    ds_read_b64_tr_b16 v[210:211], v243 offset:16896
    v_mfma_f32_32x32x16_bf16 v[176:191], v[212:215], v[44:47], v[176:191]
    s_waitcnt lgkmcnt(8)
    s_barrier
    ds_read_b64_tr_b16 v[212:213], v248 offset:13312
    ds_read_b64_tr_b16 v[214:215], v248 offset:13568
    v_mfma_f32_32x32x16_bf16 v[144:159], v[224:227], v[48:51], v[144:159]
    s_waitcnt lgkmcnt(8)
    ds_read_b64_tr_b16 v[224:225], v240 offset:20480
    ds_read_b64_tr_b16 v[226:227], v240 offset:20992
    v_mfma_f32_32x32x16_bf16 v[112:127], v[228:231], v[48:51], v[112:127]
    s_waitcnt lgkmcnt(8)
    ds_read_b64_tr_b16 v[228:229], v241 offset:20480
    ds_read_b64_tr_b16 v[230:231], v241 offset:20992
    v_mfma_f32_32x32x16_bf16 v[128:143], v[232:235], v[48:51], v[128:143]
    s_waitcnt lgkmcnt(8)
    ds_read_b64_tr_b16 v[232:233], v242 offset:20480
    ds_read_b64_tr_b16 v[234:235], v242 offset:20992
    v_mfma_f32_32x32x16_bf16 v[160:175], v[236:239], v[48:51], v[160:175]
    s_waitcnt lgkmcnt(8)
    ds_read_b64_tr_b16 v[236:237], v243 offset:20480
    ds_read_b64_tr_b16 v[238:239], v243 offset:20992
    v_mfma_f32_32x32x16_bf16 v[176:191], v[208:211], v[48:51], v[176:191]
    s_waitcnt lgkmcnt(8)
    ds_read_b64_tr_b16 v[208:209], v248 offset:14336
    ds_read_b64_tr_b16 v[210:211], v248 offset:14592
    v_mfma_f32_32x32x16_bf16 v[144:159], v[212:215], v[52:55], v[144:159]
    s_waitcnt lgkmcnt(8)
    ds_read_b64_tr_b16 v[212:213], v240 offset:24576
    ds_read_b64_tr_b16 v[214:215], v240 offset:25088
    v_mfma_f32_32x32x16_bf16 v[112:127], v[224:227], v[52:55], v[112:127]
    s_waitcnt lgkmcnt(8)
    ds_read_b64_tr_b16 v[224:225], v241 offset:24576
    ds_read_b64_tr_b16 v[226:227], v241 offset:25088
    v_mfma_f32_32x32x16_bf16 v[128:143], v[228:231], v[52:55], v[128:143]
    s_waitcnt lgkmcnt(8)
    ds_read_b64_tr_b16 v[228:229], v242 offset:24576
    ds_read_b64_tr_b16 v[230:231], v242 offset:25088
    v_mfma_f32_32x32x16_bf16 v[160:175], v[232:235], v[52:55], v[160:175]
    s_waitcnt lgkmcnt(8)
    ds_read_b64_tr_b16 v[232:233], v243 offset:24576
    ds_read_b64_tr_b16 v[234:235], v243 offset:25088
    v_mfma_f32_32x32x16_bf16 v[176:191], v[236:239], v[52:55], v[176:191]
    s_waitcnt lgkmcnt(8)
    ds_read_b64_tr_b16 v[236:237], v248 offset:15360
    ds_read_b64_tr_b16 v[238:239], v248 offset:15616
    v_mfma_f32_32x32x16_bf16 v[144:159], v[208:211], v[56:59], v[144:159]
    s_waitcnt lgkmcnt(8)
    ds_read_b64_tr_b16 v[208:209], v240 offset:28672
    ds_read_b64_tr_b16 v[210:211], v240 offset:29184
    v_mfma_f32_32x32x16_bf16 v[112:127], v[212:215], v[56:59], v[112:127]
    s_waitcnt lgkmcnt(8)
    ds_read_b64_tr_b16 v[212:213], v241 offset:28672
    ds_read_b64_tr_b16 v[214:215], v241 offset:29184
    v_mfma_f32_32x32x16_bf16 v[128:143], v[224:227], v[56:59], v[128:143]
    s_waitcnt lgkmcnt(8)
    ds_read_b64_tr_b16 v[224:225], v242 offset:28672
    ds_read_b64_tr_b16 v[226:227], v242 offset:29184
    v_mfma_f32_32x32x16_bf16 v[160:175], v[228:231], v[56:59], v[160:175]
    s_waitcnt lgkmcnt(8)
    ds_read_b64_tr_b16 v[228:229], v243 offset:28672
    ds_read_b64_tr_b16 v[230:231], v243 offset:29184
    v_mfma_f32_32x32x16_bf16 v[176:191], v[232:235], v[56:59], v[176:191]
    s_waitcnt lgkmcnt(8)
    s_barrier
    ds_read_b64_tr_b16 v[232:233], v240 offset:32768
    ds_read_b64_tr_b16 v[234:235], v240 offset:33280
    v_mfma_f32_32x32x16_bf16 v[144:159], v[236:239], v[60:63], v[144:159]
    s_waitcnt lgkmcnt(8)
    ds_read_b64_tr_b16 v[236:237], v240 offset:36864
    ds_read_b64_tr_b16 v[238:239], v240 offset:37376
    v_mfma_f32_32x32x16_bf16 v[112:127], v[208:211], v[60:63], v[112:127]
    s_waitcnt lgkmcnt(8)
    ds_read_b64_tr_b16 v[208:209], v240 offset:40960
    ds_read_b64_tr_b16 v[210:211], v240 offset:41472
    v_mfma_f32_32x32x16_bf16 v[128:143], v[212:215], v[60:63], v[128:143]
    s_waitcnt lgkmcnt(8)
    ds_read_b64_tr_b16 v[212:213], v240 offset:45056
    ds_read_b64_tr_b16 v[214:215], v240 offset:45568
    v_mfma_f32_32x32x16_bf16 v[160:175], v[224:227], v[60:63], v[160:175]
    s_waitcnt lgkmcnt(8)
    ds_read_b64_tr_b16 v[224:225], v240 offset:49152
    ds_read_b64_tr_b16 v[226:227], v240 offset:49664
    v_mfma_f32_32x32x16_bf16 v[176:191], v[228:231], v[60:63], v[176:191]
    s_waitcnt lgkmcnt(8)
    ds_read_b64_tr_b16 v[228:229], v240 offset:53248
    ds_read_b64_tr_b16 v[230:231], v240 offset:53760
    v_mfma_f32_32x32x16_bf16 v[112:127], v[232:235], v[64:67], v[112:127]
    s_waitcnt lgkmcnt(8)
    ds_read_b64_tr_b16 v[232:233], v240 offset:57344
    ds_read_b64_tr_b16 v[234:235], v240 offset:57856
    v_mfma_f32_32x32x16_bf16 v[112:127], v[236:239], v[68:71], v[112:127]
    s_waitcnt lgkmcnt(8)
    ds_read_b64_tr_b16 v[236:237], v240 offset:61440
    ds_read_b64_tr_b16 v[238:239], v240 offset:61952
    v_add_u32 v240, 32768, v240
    v_mfma_f32_32x32x16_bf16 v[112:127], v[208:211], v[72:75], v[112:127]
    s_waitcnt lgkmcnt(8)
    ds_read_b64_tr_b16 v[208:209], v240 offset:32768
    ds_read_b64_tr_b16 v[210:211], v240 offset:33280
    v_mfma_f32_32x32x16_bf16 v[112:127], v[212:215], v[76:79], v[112:127]
    s_waitcnt lgkmcnt(8)
    ds_read_b64_tr_b16 v[212:213], v240 offset:40960
    ds_read_b64_tr_b16 v[214:215], v240 offset:41472
    v_mfma_f32_32x32x16_bf16 v[112:127], v[224:227], v[80:83], v[112:127]
    s_waitcnt lgkmcnt(8)
    ds_read_b64_tr_b16 v[224:225], v240 offset:45056
    ds_read_b64_tr_b16 v[226:227], v240 offset:45568
    v_mfma_f32_32x32x16_bf16 v[112:127], v[228:231], v[84:87], v[112:127]
    s_waitcnt lgkmcnt(8)
    ds_read_b64_tr_b16 v[228:229], v240 offset:49152
    ds_read_b64_tr_b16 v[230:231], v240 offset:49664
    v_mfma_f32_32x32x16_bf16 v[112:127], v[232:235], v[88:91], v[112:127]
    s_waitcnt lgkmcnt(8)
    ds_read_b64_tr_b16 v[232:233], v241 offset:32768
    ds_read_b64_tr_b16 v[234:235], v241 offset:33280
    v_mfma_f32_32x32x16_bf16 v[112:127], v[236:239], v[92:95], v[112:127]
    s_waitcnt lgkmcnt(8)
    ds_read_b64_tr_b16 v[236:237], v241 offset:36864
    ds_read_b64_tr_b16 v[238:239], v241 offset:37376
    v_mfma_f32_32x32x16_bf16 v[112:127], v[208:211], v[96:99], v[112:127]
    s_waitcnt lgkmcnt(8)
    ds_read_b64_tr_b16 v[208:209], v241 offset:40960
    ds_read_b64_tr_b16 v[210:211], v241 offset:41472
    v_mfma_f32_32x32x16_bf16 v[112:127], v[212:215], v[100:103], v[112:127]
    s_waitcnt lgkmcnt(8)
    s_barrier
    ds_read_b64_tr_b16 v[212:213], v241 offset:45056
    ds_read_b64_tr_b16 v[214:215], v241 offset:45568
    v_mfma_f32_32x32x16_bf16 v[112:127], v[224:227], v[104:107], v[112:127]
    s_waitcnt lgkmcnt(8)
    ds_read_b64_tr_b16 v[224:225], v241 offset:49152
    ds_read_b64_tr_b16 v[226:227], v241 offset:49664
    v_mfma_f32_32x32x16_bf16 v[112:127], v[228:231], v[108:111], v[112:127]
    s_waitcnt lgkmcnt(8)
    ds_read_b64_tr_b16 v[228:229], v241 offset:53248
    ds_read_b64_tr_b16 v[230:231], v241 offset:53760
    v_mfma_f32_32x32x16_bf16 v[128:143], v[232:235], v[64:67], v[128:143]
    s_waitcnt lgkmcnt(8)
    ds_read_b64_tr_b16 v[232:233], v241 offset:57344
    ds_read_b64_tr_b16 v[234:235], v241 offset:57856
    v_mfma_f32_32x32x16_bf16 v[128:143], v[236:239], v[68:71], v[128:143]
    s_waitcnt lgkmcnt(8)
    ds_read_b64_tr_b16 v[236:237], v241 offset:61440
    ds_read_b64_tr_b16 v[238:239], v241 offset:61952
    v_add_u32 v241, 32768, v241
    v_mfma_f32_32x32x16_bf16 v[128:143], v[208:211], v[72:75], v[128:143]
    s_waitcnt lgkmcnt(8)
    ds_read_b64_tr_b16 v[208:209], v241 offset:32768
    ds_read_b64_tr_b16 v[210:211], v241 offset:33280
    v_mul_f32 v250, v112, v112
    v_mul_f32 v251, v113, v113
    v_fma_f32 v250, v250, v246, v245
    v_fma_f32 v251, v251, v246, v245
    v_mfma_f32_32x32x16_bf16 v[128:143], v[212:215], v[76:79], v[128:143]
    s_waitcnt lgkmcnt(8)
    ds_read_b64_tr_b16 v[212:213], v241 offset:40960
    ds_read_b64_tr_b16 v[214:215], v241 offset:41472
    v_mul_f32 v250, v250, v112
    v_mul_f32 v251, v251, v113
    v_mul_f32 v116, v112, v116
    v_mul_f32 v117, v113, v117
    v_mfma_f32_32x32x16_bf16 v[128:143], v[224:227], v[80:83], v[128:143]
    s_waitcnt lgkmcnt(8)
    ds_read_b64_tr_b16 v[224:225], v241 offset:45056
    ds_read_b64_tr_b16 v[226:227], v241 offset:45568
    v_exp_f32 v112, v250
    v_exp_f32 v113, v251
    v_mfma_f32_32x32x16_bf16 v[128:143], v[228:231], v[84:87], v[128:143]
    s_waitcnt lgkmcnt(8)
    ds_read_b64_tr_b16 v[228:229], v241 offset:49152
    ds_read_b64_tr_b16 v[230:231], v241 offset:49664
    v_mul_f32 v250, v114, v114
    v_mul_f32 v251, v115, v115
    v_fma_f32 v112, v112, v247, v247
    v_fma_f32 v113, v113, v247, v247
    v_mfma_f32_32x32x16_bf16 v[128:143], v[232:235], v[88:91], v[128:143]
    s_waitcnt lgkmcnt(8)
    ds_read_b64_tr_b16 v[232:233], v242 offset:32768
    ds_read_b64_tr_b16 v[234:235], v242 offset:33280
    v_fma_f32 v250, v250, v246, v245
    v_fma_f32 v251, v251, v246, v245
    v_rcp_f32 v112, v112
    v_mfma_f32_32x32x16_bf16 v[128:143], v[236:239], v[92:95], v[128:143]
    s_waitcnt lgkmcnt(8)
    ds_read_b64_tr_b16 v[236:237], v242 offset:36864
    ds_read_b64_tr_b16 v[238:239], v242 offset:37376
    v_rcp_f32 v113, v113
    v_mul_f32 v250, v250, v114
    v_mul_f32 v251, v251, v115
    v_mfma_f32_32x32x16_bf16 v[128:143], v[208:211], v[96:99], v[128:143]
    s_waitcnt lgkmcnt(8)
    ds_read_b64_tr_b16 v[208:209], v242 offset:40960
    ds_read_b64_tr_b16 v[210:211], v242 offset:41472
    v_mul_f32 v118, v114, v118
    v_mul_f32 v119, v115, v119
    v_mul_f32 v116, v116, v112
    v_mul_f32 v117, v117, v113
    v_mfma_f32_32x32x16_bf16 v[128:143], v[212:215], v[100:103], v[128:143]
    s_waitcnt lgkmcnt(8)
    ds_read_b64_tr_b16 v[212:213], v242 offset:45056
    ds_read_b64_tr_b16 v[214:215], v242 offset:45568
    v_exp_f32 v114, v250
    v_exp_f32 v115, v251
    v_mfma_f32_32x32x16_bf16 v[128:143], v[224:227], v[104:107], v[128:143]
    s_waitcnt lgkmcnt(8)
    ds_read_b64_tr_b16 v[224:225], v242 offset:49152
    ds_read_b64_tr_b16 v[226:227], v242 offset:49664
    v_mul_f32 v250, v120, v120
    v_mul_f32 v251, v121, v121
    v_fma_f32 v114, v114, v247, v247
    v_fma_f32 v115, v115, v247, v247
    v_mfma_f32_32x32x16_bf16 v[128:143], v[228:231], v[108:111], v[128:143]
    s_waitcnt lgkmcnt(8)
    ds_read_b64_tr_b16 v[228:229], v242 offset:53248
    ds_read_b64_tr_b16 v[230:231], v242 offset:53760
    v_fma_f32 v250, v250, v246, v245
    v_fma_f32 v251, v251, v246, v245
    v_rcp_f32 v114, v114
    v_mfma_f32_32x32x16_bf16 v[160:175], v[232:235], v[64:67], v[160:175]
    s_waitcnt lgkmcnt(8)
    s_barrier
    ds_read_b64_tr_b16 v[232:233], v242 offset:57344
    ds_read_b64_tr_b16 v[234:235], v242 offset:57856
    v_rcp_f32 v115, v115
    v_mul_f32 v250, v250, v120
    v_mul_f32 v251, v251, v121
    v_mfma_f32_32x32x16_bf16 v[160:175], v[236:239], v[68:71], v[160:175]
    s_waitcnt lgkmcnt(8)
    ds_read_b64_tr_b16 v[236:237], v242 offset:61440
    ds_read_b64_tr_b16 v[238:239], v242 offset:61952
    v_mul_f32 v124, v120, v124
    v_mul_f32 v125, v121, v125
    v_mul_f32 v118, v118, v114
    v_add_u32 v242, 32768, v242
    v_mfma_f32_32x32x16_bf16 v[160:175], v[208:211], v[72:75], v[160:175]
    s_waitcnt lgkmcnt(8)
    ds_read_b64_tr_b16 v[208:209], v242 offset:32768
    ds_read_b64_tr_b16 v[210:211], v242 offset:33280
    v_mul_f32 v119, v119, v115
    v_exp_f32 v120, v250
    v_exp_f32 v121, v251
    v_mfma_f32_32x32x16_bf16 v[160:175], v[212:215], v[76:79], v[160:175]
    s_waitcnt lgkmcnt(8)
    ds_read_b64_tr_b16 v[212:213], v242 offset:40960
    ds_read_b64_tr_b16 v[214:215], v242 offset:41472
    v_mul_f32 v250, v122, v122
    v_mul_f32 v251, v123, v123
    v_fma_f32 v120, v120, v247, v247
    v_fma_f32 v121, v121, v247, v247
    v_mfma_f32_32x32x16_bf16 v[160:175], v[224:227], v[80:83], v[160:175]
    s_waitcnt lgkmcnt(8)
    ds_read_b64_tr_b16 v[224:225], v242 offset:45056
    ds_read_b64_tr_b16 v[226:227], v242 offset:45568
    v_fma_f32 v250, v250, v246, v245
    v_fma_f32 v251, v251, v246, v245
    v_rcp_f32 v120, v120
    v_mfma_f32_32x32x16_bf16 v[160:175], v[228:231], v[84:87], v[160:175]
    s_waitcnt lgkmcnt(8)
    ds_read_b64_tr_b16 v[228:229], v242 offset:49152
    ds_read_b64_tr_b16 v[230:231], v242 offset:49664
    v_rcp_f32 v121, v121
    v_mul_f32 v250, v250, v122
    v_mul_f32 v251, v251, v123
    v_mfma_f32_32x32x16_bf16 v[160:175], v[232:235], v[88:91], v[160:175]
    s_waitcnt lgkmcnt(8)
    ds_read_b64_tr_b16 v[232:233], v243 offset:32768
    ds_read_b64_tr_b16 v[234:235], v243 offset:33280
    v_mul_f32 v126, v122, v126
    v_mul_f32 v127, v123, v127
    v_mul_f32 v124, v124, v120
    v_mul_f32 v125, v125, v121
    v_mfma_f32_32x32x16_bf16 v[160:175], v[236:239], v[92:95], v[160:175]
    s_waitcnt lgkmcnt(8)
    ds_read_b64_tr_b16 v[236:237], v243 offset:36864
    ds_read_b64_tr_b16 v[238:239], v243 offset:37376
    v_exp_f32 v122, v250
    v_exp_f32 v123, v251
    v_mfma_f32_32x32x16_bf16 v[160:175], v[208:211], v[96:99], v[160:175]
    s_waitcnt lgkmcnt(8)
    ds_read_b64_tr_b16 v[208:209], v243 offset:40960
    ds_read_b64_tr_b16 v[210:211], v243 offset:41472
    v_cvt_pk_bf16_f32 v112, v116, v117
    v_cvt_pk_bf16_f32 v113, v118, v119
    v_fma_f32 v122, v122, v247, v247
    v_fma_f32 v123, v123, v247, v247
    v_mfma_f32_32x32x16_bf16 v[160:175], v[212:215], v[100:103], v[160:175]
    s_waitcnt lgkmcnt(8)
    ds_read_b64_tr_b16 v[212:213], v243 offset:45056
    ds_read_b64_tr_b16 v[214:215], v243 offset:45568
    v_cvt_pk_bf16_f32 v114, v124, v125
    v_rcp_f32 v122, v122
    v_rcp_f32 v123, v123
    v_mfma_f32_32x32x16_bf16 v[160:175], v[224:227], v[104:107], v[160:175]
    s_waitcnt lgkmcnt(8)
    ds_read_b64_tr_b16 v[224:225], v243 offset:49152
    ds_read_b64_tr_b16 v[226:227], v243 offset:49664
    v_mul_f32 v126, v126, v122
    v_mul_f32 v127, v127, v123
    v_cvt_pk_bf16_f32 v115, v126, v127
    v_mfma_f32_32x32x16_bf16 v[160:175], v[228:231], v[108:111], v[160:175]
    s_waitcnt lgkmcnt(8)
    ds_read_b64_tr_b16 v[228:229], v243 offset:53248
    ds_read_b64_tr_b16 v[230:231], v243 offset:53760
    buffer_store_dwordx4 v[112:115], v244, s[20:23], s50 offen offset:0 sc1
    v_mul_f32 v250, v128, v128
    v_mul_f32 v251, v129, v129
    v_fma_f32 v250, v250, v246, v245
    v_mfma_f32_32x32x16_bf16 v[176:191], v[232:235], v[64:67], v[176:191]
    s_waitcnt lgkmcnt(8)
    ds_read_b64_tr_b16 v[232:233], v243 offset:57344
    ds_read_b64_tr_b16 v[234:235], v243 offset:57856
    v_fma_f32 v251, v251, v246, v245
    v_mul_f32 v250, v250, v128
    v_mul_f32 v251, v251, v129
    v_mul_f32 v132, v128, v132
    v_mfma_f32_32x32x16_bf16 v[176:191], v[236:239], v[68:71], v[176:191]
    s_waitcnt lgkmcnt(8)
    ds_read_b64_tr_b16 v[236:237], v243 offset:61440
    ds_read_b64_tr_b16 v[238:239], v243 offset:61952
    v_mul_f32 v133, v129, v133
    v_exp_f32 v128, v250
    v_add_u32 v243, 32768, v243
    v_mfma_f32_32x32x16_bf16 v[176:191], v[208:211], v[72:75], v[176:191]
    s_waitcnt lgkmcnt(8)
    ds_read_b64_tr_b16 v[208:209], v243 offset:32768
    ds_read_b64_tr_b16 v[210:211], v243 offset:33280
    v_exp_f32 v129, v251
    v_mul_f32 v250, v130, v130
    v_mul_f32 v251, v131, v131
    v_mfma_f32_32x32x16_bf16 v[176:191], v[212:215], v[76:79], v[176:191]
    s_waitcnt lgkmcnt(8)
    s_barrier
    ds_read_b64_tr_b16 v[212:213], v243 offset:40960
    ds_read_b64_tr_b16 v[214:215], v243 offset:41472
    v_fma_f32 v128, v128, v247, v247
    v_fma_f32 v129, v129, v247, v247
    v_fma_f32 v250, v250, v246, v245
    v_fma_f32 v251, v251, v246, v245
    v_mfma_f32_32x32x16_bf16 v[176:191], v[224:227], v[80:83], v[176:191]
    s_waitcnt lgkmcnt(8)
    ds_read_b64_tr_b16 v[224:225], v243 offset:45056
    ds_read_b64_tr_b16 v[226:227], v243 offset:45568
    v_rcp_f32 v128, v128
    v_rcp_f32 v129, v129
    v_mfma_f32_32x32x16_bf16 v[176:191], v[228:231], v[84:87], v[176:191]
    s_waitcnt lgkmcnt(8)
    ds_read_b64_tr_b16 v[228:229], v243 offset:49152
    ds_read_b64_tr_b16 v[230:231], v243 offset:49664
    v_mul_f32 v250, v250, v130
    v_mul_f32 v251, v251, v131
    v_mul_f32 v134, v130, v134
    v_add_u32 v248, 32768, v248
    v_mfma_f32_32x32x16_bf16 v[176:191], v[232:235], v[88:91], v[176:191]
    s_waitcnt lgkmcnt(8)
    ds_read_b64_tr_b16 v[232:233], v248 offset:53248
    ds_read_b64_tr_b16 v[234:235], v248 offset:53504
    v_mul_f32 v135, v131, v135
    v_mul_f32 v132, v132, v128
    v_mul_f32 v133, v133, v129
    v_exp_f32 v130, v250
    v_mfma_f32_32x32x16_bf16 v[176:191], v[236:239], v[92:95], v[176:191]
    s_waitcnt lgkmcnt(8)
    ds_read_b64_tr_b16 v[236:237], v248 offset:54272
    ds_read_b64_tr_b16 v[238:239], v248 offset:54528
    v_exp_f32 v131, v251
    v_mul_f32 v250, v136, v136
    v_mul_f32 v251, v137, v137
    v_mfma_f32_32x32x16_bf16 v[176:191], v[208:211], v[96:99], v[176:191]
    s_waitcnt lgkmcnt(8)
    ds_read_b64_tr_b16 v[208:209], v248 offset:55296
    ds_read_b64_tr_b16 v[210:211], v248 offset:55552
    v_fma_f32 v130, v130, v247, v247
    v_fma_f32 v131, v131, v247, v247
    v_fma_f32 v250, v250, v246, v245
    v_fma_f32 v251, v251, v246, v245
    v_mfma_f32_32x32x16_bf16 v[176:191], v[212:215], v[100:103], v[176:191]
    s_waitcnt lgkmcnt(8)
    ds_read_b64_tr_b16 v[212:213], v248 offset:56320
    ds_read_b64_tr_b16 v[214:215], v248 offset:56576
    v_rcp_f32 v130, v130
    v_rcp_f32 v131, v131
    v_mfma_f32_32x32x16_bf16 v[176:191], v[224:227], v[104:107], v[176:191]
    s_waitcnt lgkmcnt(8)
    ds_read_b64_tr_b16 v[224:225], v248 offset:61440
    ds_read_b64_tr_b16 v[226:227], v248 offset:61696
    v_mul_f32 v250, v250, v136
    v_mul_f32 v251, v251, v137
    v_mul_f32 v140, v136, v140
    v_mul_f32 v141, v137, v141
    v_mfma_f32_32x32x16_bf16 v[176:191], v[228:231], v[108:111], v[176:191]
    s_waitcnt lgkmcnt(8)
    ds_read_b64_tr_b16 v[228:229], v248 offset:62464
    ds_read_b64_tr_b16 v[230:231], v248 offset:62720
    v_mul_f32 v134, v134, v130
    v_mul_f32 v135, v135, v131
    v_exp_f32 v136, v250
    v_mfma_f32_32x32x16_bf16 v[144:159], v[232:235], v[64:67], v[144:159]
    s_waitcnt lgkmcnt(8)
    ds_read_b64_tr_b16 v[232:233], v248 offset:63488
    ds_read_b64_tr_b16 v[234:235], v248 offset:63744
    v_exp_f32 v137, v251
    v_mul_f32 v250, v138, v138
    v_mul_f32 v251, v139, v139
    v_mfma_f32_32x32x16_bf16 v[144:159], v[236:239], v[68:71], v[144:159]
    s_waitcnt lgkmcnt(8)
    ds_read_b64_tr_b16 v[236:237], v248 offset:64512
    ds_read_b64_tr_b16 v[238:239], v248 offset:64768
    v_fma_f32 v136, v136, v247, v247
    v_fma_f32 v137, v137, v247, v247
    v_fma_f32 v250, v250, v246, v245
    v_fma_f32 v251, v251, v246, v245
    v_mfma_f32_32x32x16_bf16 v[144:159], v[208:211], v[72:75], v[144:159]
    s_waitcnt lgkmcnt(8)
    ds_read_b64_tr_b16 v[208:209], v248 offset:36864
    ds_read_b64_tr_b16 v[210:211], v248 offset:37120
    v_rcp_f32 v136, v136
    v_rcp_f32 v137, v137
    v_mfma_f32_32x32x16_bf16 v[144:159], v[212:215], v[76:79], v[144:159]
    s_waitcnt lgkmcnt(8)
    ds_read_b64_tr_b16 v[212:213], v248 offset:37888
    ds_read_b64_tr_b16 v[214:215], v248 offset:38144
    v_mul_f32 v250, v250, v138
    v_mul_f32 v251, v251, v139
    v_mul_f32 v142, v138, v142
    v_mul_f32 v143, v139, v143
    v_mfma_f32_32x32x16_bf16 v[144:159], v[224:227], v[80:83], v[144:159]
    s_waitcnt lgkmcnt(8)
    ds_read_b64_tr_b16 v[224:225], v248 offset:38912
    ds_read_b64_tr_b16 v[226:227], v248 offset:39168
    v_mul_f32 v140, v140, v136
    v_mul_f32 v141, v141, v137
    v_exp_f32 v138, v250
    v_mfma_f32_32x32x16_bf16 v[144:159], v[228:231], v[84:87], v[144:159]
    s_waitcnt lgkmcnt(8)
    ds_read_b64_tr_b16 v[228:229], v248 offset:39936
    ds_read_b64_tr_b16 v[230:231], v248 offset:40192
    v_exp_f32 v139, v251
    v_cvt_pk_bf16_f32 v128, v132, v133
    v_cvt_pk_bf16_f32 v129, v134, v135
    v_mfma_f32_32x32x16_bf16 v[144:159], v[232:235], v[88:91], v[144:159]
    s_waitcnt lgkmcnt(8)
    s_barrier
    ds_read_b64_tr_b16 v[232:233], v240 offset:57344
    ds_read_b64_tr_b16 v[234:235], v240 offset:57856
    v_fma_f32 v138, v138, v247, v247
    v_fma_f32 v139, v139, v247, v247
    v_cvt_pk_bf16_f32 v130, v140, v141
    v_rcp_f32 v138, v138
    v_mfma_f32_32x32x16_bf16 v[144:159], v[236:239], v[92:95], v[144:159]
    s_waitcnt lgkmcnt(8)
    ds_read_b64_tr_b16 v[236:237], v241 offset:57344
    ds_read_b64_tr_b16 v[238:239], v241 offset:57856
    v_rcp_f32 v139, v139
    v_mul_f32 v142, v142, v138
    v_mul_f32 v143, v143, v139
    v_mfma_f32_32x32x16_bf16 v[144:159], v[208:211], v[96:99], v[144:159]
    s_waitcnt lgkmcnt(8)
    ds_read_b64_tr_b16 v[252:253], v242 offset:57344
    ds_read_b64_tr_b16 v[254:255], v242 offset:57856
    v_cvt_pk_bf16_f32 v131, v142, v143
    v_mfma_f32_32x32x16_bf16 v[144:159], v[212:215], v[100:103], v[144:159]
    s_waitcnt lgkmcnt(8)
    buffer_store_dwordx4 v[128:131], v244, s[20:23], s50 offen offset:1024 sc1
    v_mul_f32 v250, v160, v160
    v_mul_f32 v251, v161, v161
    v_fma_f32 v250, v250, v246, v245
    v_fma_f32 v251, v251, v246, v245
    v_mfma_f32_32x32x16_bf16 v[144:159], v[224:227], v[104:107], v[144:159]
    s_waitcnt lgkmcnt(6)
    ds_read_b64_tr_b16 v[224:225], v243 offset:57344
    ds_read_b64_tr_b16 v[226:227], v243 offset:57856
    v_mul_f32 v250, v250, v160
    v_mul_f32 v251, v251, v161
    v_mul_f32 v164, v160, v164
    v_add_u32 v240, -32768, v240
    v_mfma_f32_32x32x16_bf16 v[144:159], v[228:231], v[108:111], v[144:159]
    s_waitcnt lgkmcnt(6)
    s_barrier
    ds_read_b64_tr_b16 v[228:229], v240 offset:0
    ds_read_b64_tr_b16 v[230:231], v240 offset:512
    v_mul_f32 v165, v161, v165
    v_exp_f32 v160, v250
    v_add_u32 v241, -32768, v241
    v_mfma_f32_32x32x16_bf16 v[192:207], v[232:235], v[0:3], 0
    s_waitcnt lgkmcnt(6)
    ds_read_b64_tr_b16 v[232:233], v241 offset:0
    ds_read_b64_tr_b16 v[234:235], v241 offset:512
    v_exp_f32 v161, v251
    v_mul_f32 v250, v162, v162
    v_add_u32 v242, -32768, v242
    v_mfma_f32_32x32x16_bf16 v[208:223], v[236:239], v[0:3], 0
    s_waitcnt lgkmcnt(6)
    ds_read_b64_tr_b16 v[236:237], v242 offset:0
    ds_read_b64_tr_b16 v[238:239], v242 offset:512
    v_mul_f32 v251, v163, v163
    v_fma_f32 v160, v160, v247, v247
    v_fma_f32 v161, v161, v247, v247
    v_add_u32 v243, -32768, v243
    v_mfma_f32_32x32x16_bf16 v[112:127], v[252:255], v[0:3], 0
    s_waitcnt lgkmcnt(6)
    ds_read_b64_tr_b16 v[252:253], v243 offset:0
    ds_read_b64_tr_b16 v[254:255], v243 offset:512
    v_fma_f32 v250, v250, v246, v245
    v_fma_f32 v251, v251, v246, v245
    v_rcp_f32 v160, v160
    v_mfma_f32_32x32x16_bf16 v[128:143], v[224:227], v[0:3], 0
    s_waitcnt lgkmcnt(6)
    ds_read_b64_tr_b16 v[224:225], v240 offset:4096
    ds_read_b64_tr_b16 v[226:227], v240 offset:4608
    v_rcp_f32 v161, v161
    v_mul_f32 v250, v250, v162
    v_mul_f32 v251, v251, v163
    v_mfma_f32_32x32x16_bf16 v[192:207], v[228:231], v[4:7], v[192:207]
    s_waitcnt lgkmcnt(6)
    ds_read_b64_tr_b16 v[228:229], v241 offset:4096
    ds_read_b64_tr_b16 v[230:231], v241 offset:4608
    v_mul_f32 v166, v162, v166
    v_mul_f32 v167, v163, v167
    v_mul_f32 v164, v164, v160
    v_mul_f32 v165, v165, v161
    v_mfma_f32_32x32x16_bf16 v[208:223], v[232:235], v[4:7], v[208:223]
    s_waitcnt lgkmcnt(6)
    ds_read_b64_tr_b16 v[232:233], v242 offset:4096
    ds_read_b64_tr_b16 v[234:235], v242 offset:4608
    v_exp_f32 v162, v250
    v_exp_f32 v163, v251
    v_mfma_f32_32x32x16_bf16 v[112:127], v[236:239], v[4:7], v[112:127]
    s_waitcnt lgkmcnt(6)
    ds_read_b64_tr_b16 v[236:237], v243 offset:4096
    ds_read_b64_tr_b16 v[238:239], v243 offset:4608
    v_mul_f32 v250, v168, v168
    v_mul_f32 v251, v169, v169
    v_fma_f32 v162, v162, v247, v247
    v_fma_f32 v163, v163, v247, v247
    v_mfma_f32_32x32x16_bf16 v[128:143], v[252:255], v[4:7], v[128:143]
    s_waitcnt lgkmcnt(6)
    ds_read_b64_tr_b16 v[252:253], v240 offset:8192
    ds_read_b64_tr_b16 v[254:255], v240 offset:8704
    v_fma_f32 v250, v250, v246, v245
    v_fma_f32 v251, v251, v246, v245
    v_rcp_f32 v162, v162
    v_mfma_f32_32x32x16_bf16 v[192:207], v[224:227], v[8:11], v[192:207]
    s_waitcnt lgkmcnt(6)
    ds_read_b64_tr_b16 v[224:225], v241 offset:8192
    ds_read_b64_tr_b16 v[226:227], v241 offset:8704
    v_rcp_f32 v163, v163
    v_mul_f32 v250, v250, v168
    v_mul_f32 v251, v251, v169
    v_mfma_f32_32x32x16_bf16 v[208:223], v[228:231], v[8:11], v[208:223]
    s_waitcnt lgkmcnt(6)
    ds_read_b64_tr_b16 v[228:229], v242 offset:8192
    ds_read_b64_tr_b16 v[230:231], v242 offset:8704
    v_mul_f32 v172, v168, v172
    v_mul_f32 v173, v169, v173
    v_mul_f32 v166, v166, v162
    v_mul_f32 v167, v167, v163
    v_mfma_f32_32x32x16_bf16 v[112:127], v[232:235], v[8:11], v[112:127]
    s_waitcnt lgkmcnt(6)
    ds_read_b64_tr_b16 v[232:233], v243 offset:8192
    ds_read_b64_tr_b16 v[234:235], v243 offset:8704
    v_exp_f32 v168, v250
    v_exp_f32 v169, v251
    v_mfma_f32_32x32x16_bf16 v[128:143], v[236:239], v[8:11], v[128:143]
    s_waitcnt lgkmcnt(6)
    s_barrier
    ds_read_b64_tr_b16 v[236:237], v240 offset:12288
    ds_read_b64_tr_b16 v[238:239], v240 offset:12800
    v_mul_f32 v250, v170, v170
    v_mul_f32 v251, v171, v171
    v_fma_f32 v168, v168, v247, v247
    v_fma_f32 v169, v169, v247, v247
    v_mfma_f32_32x32x16_bf16 v[192:207], v[252:255], v[12:15], v[192:207]
    s_waitcnt lgkmcnt(6)
    ds_read_b64_tr_b16 v[252:253], v241 offset:12288
    ds_read_b64_tr_b16 v[254:255], v241 offset:12800
    v_fma_f32 v250, v250, v246, v245
    v_fma_f32 v251, v251, v246, v245
    v_rcp_f32 v168, v168
    v_mfma_f32_32x32x16_bf16 v[208:223], v[224:227], v[12:15], v[208:223]
    s_waitcnt lgkmcnt(6)
    ds_read_b64_tr_b16 v[224:225], v242 offset:12288
    ds_read_b64_tr_b16 v[226:227], v242 offset:12800
    v_rcp_f32 v169, v169
    v_mul_f32 v250, v250, v170
    v_mul_f32 v251, v251, v171
    v_mfma_f32_32x32x16_bf16 v[112:127], v[228:231], v[12:15], v[112:127]
    s_waitcnt lgkmcnt(6)
    ds_read_b64_tr_b16 v[228:229], v243 offset:12288
    ds_read_b64_tr_b16 v[230:231], v243 offset:12800
    v_mul_f32 v174, v170, v174
    v_mul_f32 v175, v171, v175
    v_mul_f32 v172, v172, v168
    v_mul_f32 v173, v173, v169
    v_mfma_f32_32x32x16_bf16 v[128:143], v[232:235], v[12:15], v[128:143]
    s_waitcnt lgkmcnt(6)
    ds_read_b64_tr_b16 v[232:233], v240 offset:16384
    ds_read_b64_tr_b16 v[234:235], v240 offset:16896
    v_exp_f32 v170, v250
    v_exp_f32 v171, v251
    v_mfma_f32_32x32x16_bf16 v[192:207], v[236:239], v[16:19], v[192:207]
    s_waitcnt lgkmcnt(6)
    ds_read_b64_tr_b16 v[236:237], v241 offset:16384
    ds_read_b64_tr_b16 v[238:239], v241 offset:16896
    v_cvt_pk_bf16_f32 v160, v164, v165
    v_cvt_pk_bf16_f32 v161, v166, v167
    v_fma_f32 v170, v170, v247, v247
    v_fma_f32 v171, v171, v247, v247
    v_mfma_f32_32x32x16_bf16 v[208:223], v[252:255], v[16:19], v[208:223]
    s_waitcnt lgkmcnt(6)
    ds_read_b64_tr_b16 v[252:253], v242 offset:16384
    ds_read_b64_tr_b16 v[254:255], v242 offset:16896
    v_cvt_pk_bf16_f32 v162, v172, v173
    v_rcp_f32 v170, v170
    v_rcp_f32 v171, v171
    v_mfma_f32_32x32x16_bf16 v[112:127], v[224:227], v[16:19], v[112:127]
    s_waitcnt lgkmcnt(6)
    ds_read_b64_tr_b16 v[224:225], v243 offset:16384
    ds_read_b64_tr_b16 v[226:227], v243 offset:16896
    v_mul_f32 v174, v174, v170
    v_mul_f32 v175, v175, v171
    v_cvt_pk_bf16_f32 v163, v174, v175
    v_mfma_f32_32x32x16_bf16 v[128:143], v[228:231], v[16:19], v[128:143]
    s_waitcnt lgkmcnt(6)
    ds_read_b64_tr_b16 v[228:229], v240 offset:20480
    ds_read_b64_tr_b16 v[230:231], v240 offset:20992
    buffer_store_dwordx4 v[160:163], v244, s[20:23], s50 offen offset:2048 sc1
    v_mul_f32 v144, v249, v144
    v_mul_f32 v145, v249, v145
    v_mul_f32 v146, v249, v146
    v_mfma_f32_32x32x16_bf16 v[192:207], v[232:235], v[20:23], v[192:207]
    s_waitcnt lgkmcnt(6)
    ds_read_b64_tr_b16 v[232:233], v241 offset:20480
    ds_read_b64_tr_b16 v[234:235], v241 offset:20992
    v_mul_f32 v147, v249, v147
    v_mul_f32 v148, v249, v148
    v_mul_f32 v149, v249, v149
    v_mul_f32 v150, v249, v150
    v_mfma_f32_32x32x16_bf16 v[208:223], v[236:239], v[20:23], v[208:223]
    s_waitcnt lgkmcnt(6)
    ds_read_b64_tr_b16 v[236:237], v242 offset:20480
    ds_read_b64_tr_b16 v[238:239], v242 offset:20992
    v_mul_f32 v151, v249, v151
    v_mul_f32 v152, v249, v152
    v_mul_f32 v153, v249, v153
    v_mul_f32 v154, v249, v154
    v_mfma_f32_32x32x16_bf16 v[112:127], v[252:255], v[20:23], v[112:127]
    s_waitcnt lgkmcnt(6)
    ds_read_b64_tr_b16 v[252:253], v243 offset:20480
    ds_read_b64_tr_b16 v[254:255], v243 offset:20992
    v_mul_f32 v155, v249, v155
    v_mul_f32 v156, v249, v156
    v_mul_f32 v157, v249, v157
    v_mul_f32 v158, v249, v158
    v_mfma_f32_32x32x16_bf16 v[128:143], v[224:227], v[20:23], v[128:143]
    s_waitcnt lgkmcnt(6)
    s_barrier
    ds_read_b64_tr_b16 v[224:225], v240 offset:24576
    ds_read_b64_tr_b16 v[226:227], v240 offset:25088
    v_mul_f32 v159, v249, v159
    v_cvt_pk_bf16_f32 v144, v144, v145
    v_cvt_pk_bf16_f32 v145, v146, v147
    v_cvt_pk_bf16_f32 v146, v148, v149
    v_mfma_f32_32x32x16_bf16 v[192:207], v[228:231], v[24:27], v[192:207]
    s_waitcnt lgkmcnt(6)
    ds_read_b64_tr_b16 v[228:229], v241 offset:24576
    ds_read_b64_tr_b16 v[230:231], v241 offset:25088
    v_cvt_pk_bf16_f32 v147, v150, v151
    v_cvt_pk_bf16_f32 v148, v152, v153
    v_cvt_pk_bf16_f32 v149, v154, v155
    v_cvt_pk_bf16_f32 v150, v156, v157
    v_mfma_f32_32x32x16_bf16 v[208:223], v[232:235], v[24:27], v[208:223]
    s_waitcnt lgkmcnt(6)
    ds_read_b64_tr_b16 v[232:233], v242 offset:24576
    ds_read_b64_tr_b16 v[234:235], v242 offset:25088
    v_cvt_pk_bf16_f32 v151, v158, v159
    v_add_u32 v152, s49, v244
    v_mfma_f32_32x32x16_bf16 v[112:127], v[236:239], v[24:27], v[112:127]
    s_waitcnt lgkmcnt(6)
    ds_read_b64_tr_b16 v[236:237], v243 offset:24576
    ds_read_b64_tr_b16 v[238:239], v243 offset:25088
    ds_write_b128 v152, v[144:147]
    ds_write_b128 v152, v[148:151] offset:1024
    s_lshl_b32 s53, s43, 16
    v_add_u32 v160, s53, v244
    v_mfma_f32_32x32x16_bf16 v[128:143], v[252:255], v[24:27], v[128:143]
    s_waitcnt lgkmcnt(8)
    ds_read_b64_tr_b16 v[252:253], v240 offset:28672
    ds_read_b64_tr_b16 v[254:255], v240 offset:29184
    s_lshr_b32 s52, s2, 3
    s_lshl_b32 s52, s52, 12
    s_and_b32 s52, s52, 0xffff
    s_add_u32 s53, s43, 1
    v_mfma_f32_32x32x16_bf16 v[192:207], v[224:227], v[28:31], v[192:207]
    s_waitcnt lgkmcnt(8)
    ds_read_b64_tr_b16 v[224:225], v241 offset:28672
    ds_read_b64_tr_b16 v[226:227], v241 offset:29184
    s_and_b32 s53, s53, 3
    s_lshl_b32 s53, s53, 11
    s_add_u32 s53, s53, 57344
    v_add_u32 v161, s53, v244
    v_mfma_f32_32x32x16_bf16 v[208:223], v[228:231], v[28:31], v[208:223]
    s_waitcnt lgkmcnt(8)
    ds_read_b64_tr_b16 v[228:229], v242 offset:28672
    ds_read_b64_tr_b16 v[230:231], v242 offset:29184
    s_add_u32 s53, s43, 2
    s_and_b32 s53, s53, 3
    s_lshl_b32 s53, s53, 11
    s_add_u32 s53, s53, 57344
    v_mfma_f32_32x32x16_bf16 v[112:127], v[232:235], v[28:31], v[112:127]
    s_waitcnt lgkmcnt(8)
    ds_read_b64_tr_b16 v[232:233], v243 offset:28672
    ds_read_b64_tr_b16 v[234:235], v243 offset:29184
    v_add_u32 v162, s53, v244
    s_add_u32 s53, s43, 3
    s_and_b32 s53, s53, 3
    s_lshl_b32 s53, s53, 11
    v_mfma_f32_32x32x16_bf16 v[128:143], v[236:239], v[28:31], v[128:143]
    s_waitcnt lgkmcnt(6)
    ds_read_b64_tr_b16 v[236:237], v240 offset:32768
    ds_read_b64_tr_b16 v[238:239], v240 offset:33280
    s_add_u32 s53, s53, 57344
    v_add_u32 v163, s53, v244
    s_add_u32 s53, s43, 4
    s_and_b32 s53, s53, 3
    v_mfma_f32_32x32x16_bf16 v[192:207], v[252:255], v[32:35], v[192:207]
    s_waitcnt lgkmcnt(6)
    ds_read_b64_tr_b16 v[252:253], v241 offset:32768
    ds_read_b64_tr_b16 v[254:255], v241 offset:33280
    s_lshl_b32 s53, s53, 11
    s_add_u32 s53, s53, 57344
    v_add_u32 v164, s53, v244
    v_mul_f32 v250, v176, v176
    v_mfma_f32_32x32x16_bf16 v[208:223], v[224:227], v[32:35], v[208:223]
    s_waitcnt lgkmcnt(6)
    ds_read_b64_tr_b16 v[224:225], v242 offset:32768
    ds_read_b64_tr_b16 v[226:227], v242 offset:33280
    v_mul_f32 v251, v177, v177
    v_fma_f32 v250, v250, v246, v245
    v_fma_f32 v251, v251, v246, v245
    v_mul_f32 v250, v250, v176
    v_mfma_f32_32x32x16_bf16 v[112:127], v[228:231], v[32:35], v[112:127]
    s_waitcnt lgkmcnt(6)
    ds_read_b64_tr_b16 v[228:229], v243 offset:32768
    ds_read_b64_tr_b16 v[230:231], v243 offset:33280
    v_mul_f32 v251, v251, v177
    v_mul_f32 v180, v176, v180
    v_mul_f32 v181, v177, v181
    v_exp_f32 v176, v250
    v_mfma_f32_32x32x16_bf16 v[128:143], v[232:235], v[32:35], v[128:143]
    s_waitcnt lgkmcnt(6)
    s_barrier
    ds_read_b64_tr_b16 v[232:233], v240 offset:36864
    ds_read_b64_tr_b16 v[234:235], v240 offset:37376
    v_exp_f32 v177, v251
    v_mul_f32 v250, v178, v178
    v_mul_f32 v251, v179, v179
    v_mfma_f32_32x32x16_bf16 v[192:207], v[236:239], v[36:39], v[192:207]
    s_waitcnt lgkmcnt(6)
    ds_read_b64_tr_b16 v[236:237], v241 offset:36864
    ds_read_b64_tr_b16 v[238:239], v241 offset:37376
    v_fma_f32 v176, v176, v247, v247
    v_fma_f32 v177, v177, v247, v247
    v_fma_f32 v250, v250, v246, v245
    v_fma_f32 v251, v251, v246, v245
    v_mfma_f32_32x32x16_bf16 v[208:223], v[252:255], v[36:39], v[208:223]
    s_waitcnt lgkmcnt(6)
    ds_read_b64_tr_b16 v[252:253], v242 offset:36864
    ds_read_b64_tr_b16 v[254:255], v242 offset:37376
    v_rcp_f32 v176, v176
    v_rcp_f32 v177, v177
    v_mfma_f32_32x32x16_bf16 v[112:127], v[224:227], v[36:39], v[112:127]
    s_waitcnt lgkmcnt(6)
    ds_read_b64_tr_b16 v[224:225], v243 offset:36864
    ds_read_b64_tr_b16 v[226:227], v243 offset:37376
    v_mul_f32 v250, v250, v178
    v_mul_f32 v251, v251, v179
    v_mul_f32 v182, v178, v182
    v_mul_f32 v183, v179, v183
    v_mfma_f32_32x32x16_bf16 v[128:143], v[228:231], v[36:39], v[128:143]
    s_waitcnt lgkmcnt(6)
    ds_read_b64_tr_b16 v[228:229], v240 offset:40960
    ds_read_b64_tr_b16 v[230:231], v240 offset:41472
    v_mul_f32 v180, v180, v176
    v_mul_f32 v181, v181, v177
    v_exp_f32 v178, v250
    v_mfma_f32_32x32x16_bf16 v[192:207], v[232:235], v[40:43], v[192:207]
    s_waitcnt lgkmcnt(6)
    ds_read_b64_tr_b16 v[232:233], v241 offset:40960
    ds_read_b64_tr_b16 v[234:235], v241 offset:41472
    v_exp_f32 v179, v251
    v_mul_f32 v250, v184, v184
    v_mul_f32 v251, v185, v185
    v_mfma_f32_32x32x16_bf16 v[208:223], v[236:239], v[40:43], v[208:223]
    s_waitcnt lgkmcnt(6)
    ds_read_b64_tr_b16 v[236:237], v242 offset:40960
    ds_read_b64_tr_b16 v[238:239], v242 offset:41472
    v_fma_f32 v178, v178, v247, v247
    v_fma_f32 v179, v179, v247, v247
    v_fma_f32 v250, v250, v246, v245
    v_fma_f32 v251, v251, v246, v245
    v_mfma_f32_32x32x16_bf16 v[112:127], v[252:255], v[40:43], v[112:127]
    s_waitcnt lgkmcnt(6)
    ds_read_b64_tr_b16 v[252:253], v243 offset:40960
    ds_read_b64_tr_b16 v[254:255], v243 offset:41472
    v_rcp_f32 v178, v178
    v_rcp_f32 v179, v179
    v_mfma_f32_32x32x16_bf16 v[128:143], v[224:227], v[40:43], v[128:143]
    s_waitcnt lgkmcnt(6)
    ds_read_b64_tr_b16 v[224:225], v240 offset:45056
    ds_read_b64_tr_b16 v[226:227], v240 offset:45568
    v_mul_f32 v250, v250, v184
    v_mul_f32 v251, v251, v185
    v_mul_f32 v188, v184, v188
    v_mul_f32 v189, v185, v189
    v_mfma_f32_32x32x16_bf16 v[192:207], v[228:231], v[44:47], v[192:207]
    s_waitcnt lgkmcnt(6)
    ds_read_b64_tr_b16 v[228:229], v241 offset:45056
    ds_read_b64_tr_b16 v[230:231], v241 offset:45568
    v_mul_f32 v182, v182, v178
    v_mul_f32 v183, v183, v179
    v_exp_f32 v184, v250
    v_mfma_f32_32x32x16_bf16 v[208:223], v[232:235], v[44:47], v[208:223]
    s_waitcnt lgkmcnt(6)
    ds_read_b64_tr_b16 v[232:233], v242 offset:45056
    ds_read_b64_tr_b16 v[234:235], v242 offset:45568
    v_exp_f32 v185, v251
    v_mul_f32 v250, v186, v186
    v_mul_f32 v251, v187, v187
    v_mfma_f32_32x32x16_bf16 v[112:127], v[236:239], v[44:47], v[112:127]
    s_waitcnt lgkmcnt(6)
    ds_read_b64_tr_b16 v[236:237], v243 offset:45056
    ds_read_b64_tr_b16 v[238:239], v243 offset:45568
    v_fma_f32 v184, v184, v247, v247
    v_fma_f32 v185, v185, v247, v247
    v_fma_f32 v250, v250, v246, v245
    v_fma_f32 v251, v251, v246, v245
    v_mfma_f32_32x32x16_bf16 v[128:143], v[252:255], v[44:47], v[128:143]
    s_waitcnt lgkmcnt(6)
    s_barrier
    ds_read_b64_tr_b16 v[252:253], v240 offset:49152
    ds_read_b64_tr_b16 v[254:255], v240 offset:49664
    v_rcp_f32 v184, v184
    v_rcp_f32 v185, v185
    v_mfma_f32_32x32x16_bf16 v[192:207], v[224:227], v[48:51], v[192:207]
    s_waitcnt lgkmcnt(6)
    ds_read_b64_tr_b16 v[224:225], v241 offset:49152
    ds_read_b64_tr_b16 v[226:227], v241 offset:49664
    v_mul_f32 v250, v250, v186
    v_mul_f32 v251, v251, v187
    v_mul_f32 v190, v186, v190
    v_mul_f32 v191, v187, v191
    v_mfma_f32_32x32x16_bf16 v[208:223], v[228:231], v[48:51], v[208:223]
    s_waitcnt lgkmcnt(6)
    ds_read_b64_tr_b16 v[228:229], v242 offset:49152
    ds_read_b64_tr_b16 v[230:231], v242 offset:49664
    v_mul_f32 v188, v188, v184
    v_mul_f32 v189, v189, v185
    v_exp_f32 v186, v250
    v_mfma_f32_32x32x16_bf16 v[112:127], v[232:235], v[48:51], v[112:127]
    s_waitcnt lgkmcnt(6)
    ds_read_b64_tr_b16 v[232:233], v243 offset:49152
    ds_read_b64_tr_b16 v[234:235], v243 offset:49664
    v_exp_f32 v187, v251
    v_cvt_pk_bf16_f32 v176, v180, v181
    v_cvt_pk_bf16_f32 v177, v182, v183
    v_mfma_f32_32x32x16_bf16 v[128:143], v[236:239], v[48:51], v[128:143]
    s_waitcnt lgkmcnt(6)
    ds_read_b64_tr_b16 v[236:237], v240 offset:53248
    ds_read_b64_tr_b16 v[238:239], v240 offset:53760
    v_fma_f32 v186, v186, v247, v247
    v_fma_f32 v187, v187, v247, v247
    v_cvt_pk_bf16_f32 v178, v188, v189
    v_rcp_f32 v186, v186
    v_mfma_f32_32x32x16_bf16 v[192:207], v[252:255], v[52:55], v[192:207]
    s_waitcnt lgkmcnt(6)
    ds_read_b64_tr_b16 v[252:253], v240 offset:57344
    ds_read_b64_tr_b16 v[254:255], v240 offset:57856
    v_rcp_f32 v187, v187
    v_mul_f32 v190, v190, v186
    v_mul_f32 v191, v191, v187
    v_mfma_f32_32x32x16_bf16 v[208:223], v[224:227], v[52:55], v[208:223]
    s_waitcnt lgkmcnt(6)
    ds_read_b64_tr_b16 v[224:225], v240 offset:61440
    ds_read_b64_tr_b16 v[226:227], v240 offset:61952
    v_cvt_pk_bf16_f32 v179, v190, v191
    v_add_u32 v240, 32768, v240
    v_mfma_f32_32x32x16_bf16 v[112:127], v[228:231], v[52:55], v[112:127]
    s_waitcnt lgkmcnt(6)
    ds_read_b64_tr_b16 v[228:229], v240 offset:32768
    ds_read_b64_tr_b16 v[230:231], v240 offset:33280
    buffer_store_dwordx4 v[176:179], v244, s[20:23], s50 offen offset:3072 sc1
    v_mfma_f32_32x32x16_bf16 v[128:143], v[232:235], v[52:55], v[128:143]
    s_waitcnt lgkmcnt(6)
    ds_read_b64_tr_b16 v[232:233], v240 offset:40960
    ds_read_b64_tr_b16 v[234:235], v240 offset:41472
    v_mfma_f32_32x32x16_bf16 v[192:207], v[236:239], v[56:59], v[192:207]
    s_waitcnt lgkmcnt(6)
    ds_read_b64_tr_b16 v[236:237], v240 offset:45056
    ds_read_b64_tr_b16 v[238:239], v240 offset:45568
    v_mfma_f32_32x32x16_bf16 v[192:207], v[252:255], v[60:63], v[192:207]
    s_waitcnt lgkmcnt(6)
    ds_read_b64_tr_b16 v[252:253], v240 offset:49152
    ds_read_b64_tr_b16 v[254:255], v240 offset:49664
    v_mfma_f32_32x32x16_bf16 v[192:207], v[224:227], v[64:67], v[192:207]
    s_waitcnt lgkmcnt(6)
    ds_read_b64_tr_b16 v[224:225], v240 offset:53248
    ds_read_b64_tr_b16 v[226:227], v240 offset:53760
    v_mfma_f32_32x32x16_bf16 v[192:207], v[228:231], v[68:71], v[192:207]
    s_waitcnt lgkmcnt(6)
    ds_read_b64_tr_b16 v[228:229], v240 offset:61440
    ds_read_b64_tr_b16 v[230:231], v240 offset:61952
    v_mfma_f32_32x32x16_bf16 v[192:207], v[232:235], v[72:75], v[192:207]
    s_waitcnt lgkmcnt(6)
    ds_read_b64_tr_b16 v[232:233], v240 offset:36864
    ds_read_b64_tr_b16 v[234:235], v240 offset:37376
    v_mfma_f32_32x32x16_bf16 v[192:207], v[236:239], v[76:79], v[192:207]
    s_waitcnt lgkmcnt(6)
    ds_read_b64_tr_b16 v[236:237], v240 offset:57344
    ds_read_b64_tr_b16 v[238:239], v240 offset:57856
    v_add_u32 v240, -32768, v240
    v_mfma_f32_32x32x16_bf16 v[192:207], v[252:255], v[80:83], v[192:207]
    s_waitcnt lgkmcnt(6)
    s_barrier
    ds_read_b64_tr_b16 v[252:253], v240 offset:0
    ds_read_b64_tr_b16 v[254:255], v240 offset:512
    buffer_load_dwordx4 v[0:3], v160, s[20:23], s52 offen offset:0 sc1
    v_mfma_f32_32x32x16_bf16 v[192:207], v[224:227], v[84:87], v[192:207]
    s_waitcnt lgkmcnt(6)
    ds_read_b64_tr_b16 v[224:225], v240 offset:4096
    ds_read_b64_tr_b16 v[226:227], v240 offset:4608
    v_mfma_f32_32x32x16_bf16 v[192:207], v[228:231], v[88:91], v[192:207]
    s_waitcnt lgkmcnt(6)
    ds_read_b64_tr_b16 v[228:229], v240 offset:8192
    ds_read_b64_tr_b16 v[230:231], v240 offset:8704
    v_mfma_f32_32x32x16_bf16 v[192:207], v[232:235], v[92:95], v[192:207]
    s_waitcnt lgkmcnt(6)
    ds_read_b64_tr_b16 v[232:233], v241 offset:53248
    ds_read_b64_tr_b16 v[234:235], v241 offset:53760
    v_mfma_f32_32x32x16_bf16 v[192:207], v[236:239], v[96:99], v[192:207]
    s_waitcnt lgkmcnt(6)
    ds_read_b64_tr_b16 v[236:237], v241 offset:57344
    ds_read_b64_tr_b16 v[238:239], v241 offset:57856
    buffer_load_dwordx4 v[4:7], v160, s[20:23], s52 offen offset:1024 sc1
    s_mov_b32 s56, s52
    s_add_u32 s52, s52, 4096
    s_and_b32 s52, s52, 0xffff
    v_mfma_f32_32x32x16_bf16 v[192:207], v[252:255], v[100:103], v[192:207]
    s_waitcnt lgkmcnt(6)
    ds_read_b64_tr_b16 v[252:253], v241 offset:61440
    ds_read_b64_tr_b16 v[254:255], v241 offset:61952
    v_add_u32 v241, 32768, v241
    v_mfma_f32_32x32x16_bf16 v[192:207], v[224:227], v[104:107], v[192:207]
    s_waitcnt lgkmcnt(6)
    ds_read_b64_tr_b16 v[224:225], v241 offset:32768
    ds_read_b64_tr_b16 v[226:227], v241 offset:33280
    v_mfma_f32_32x32x16_bf16 v[192:207], v[228:231], v[108:111], v[192:207]
    s_waitcnt lgkmcnt(6)
    ds_read_b64_tr_b16 v[228:229], v241 offset:40960
    ds_read_b64_tr_b16 v[230:231], v241 offset:41472
    v_mfma_f32_32x32x16_bf16 v[208:223], v[232:235], v[56:59], v[208:223]
    s_waitcnt lgkmcnt(6)
    ds_read_b64_tr_b16 v[232:233], v241 offset:45056
    ds_read_b64_tr_b16 v[234:235], v241 offset:45568
    buffer_load_dwordx4 v[8:11], v160, s[20:23], s56 offen offset:2048 sc1
    v_mfma_f32_32x32x16_bf16 v[208:223], v[236:239], v[60:63], v[208:223]
    s_waitcnt lgkmcnt(6)
    ds_read_b64_tr_b16 v[236:237], v241 offset:49152
    ds_read_b64_tr_b16 v[238:239], v241 offset:49664
    v_mfma_f32_32x32x16_bf16 v[208:223], v[252:255], v[64:67], v[208:223]
    s_waitcnt lgkmcnt(6)
    ds_read_b64_tr_b16 v[252:253], v241 offset:53248
    ds_read_b64_tr_b16 v[254:255], v241 offset:53760
    v_mul_f32 v250, v192, v192
    v_mul_f32 v251, v193, v193
    v_fma_f32 v250, v250, v246, v245
    v_fma_f32 v251, v251, v246, v245
    v_mfma_f32_32x32x16_bf16 v[208:223], v[224:227], v[68:71], v[208:223]
    s_waitcnt lgkmcnt(6)
    ds_read_b64_tr_b16 v[224:225], v241 offset:61440
    ds_read_b64_tr_b16 v[226:227], v241 offset:61952
    v_mul_f32 v250, v250, v192
    v_mul_f32 v251, v251, v193
    v_mul_f32 v196, v192, v196
    v_mul_f32 v197, v193, v197
    v_mfma_f32_32x32x16_bf16 v[208:223], v[228:231], v[72:75], v[208:223]
    s_waitcnt lgkmcnt(6)
    ds_read_b64_tr_b16 v[228:229], v241 offset:36864
    ds_read_b64_tr_b16 v[230:231], v241 offset:37376
    buffer_load_dwordx4 v[12:15], v160, s[20:23], s56 offen offset:3072 sc1
    v_exp_f32 v192, v250
    v_exp_f32 v193, v251
    v_mfma_f32_32x32x16_bf16 v[208:223], v[232:235], v[76:79], v[208:223]
    s_waitcnt lgkmcnt(6)
    ds_read_b64_tr_b16 v[232:233], v241 offset:57344
    ds_read_b64_tr_b16 v[234:235], v241 offset:57856
    v_mul_f32 v250, v194, v194
    v_mul_f32 v251, v195, v195
    v_fma_f32 v192, v192, v247, v247
    v_add_u32 v241, -32768, v241
    v_mfma_f32_32x32x16_bf16 v[208:223], v[236:239], v[80:83], v[208:223]
    s_waitcnt lgkmcnt(6)
    ds_read_b64_tr_b16 v[236:237], v241 offset:0
    ds_read_b64_tr_b16 v[238:239], v241 offset:512
    v_fma_f32 v193, v193, v247, v247
    v_fma_f32 v250, v250, v246, v245
    v_fma_f32 v251, v251, v246, v245
    v_rcp_f32 v192, v192
    v_mfma_f32_32x32x16_bf16 v[208:223], v[252:255], v[84:87], v[208:223]
    s_waitcnt lgkmcnt(6)
    ds_read_b64_tr_b16 v[252:253], v241 offset:4096
    ds_read_b64_tr_b16 v[254:255], v241 offset:4608
    v_rcp_f32 v193, v193
    v_mul_f32 v250, v250, v194
    v_mul_f32 v251, v251, v195
    v_mfma_f32_32x32x16_bf16 v[208:223], v[224:227], v[88:91], v[208:223]
    s_waitcnt lgkmcnt(6)
    ds_read_b64_tr_b16 v[224:225], v241 offset:8192
    ds_read_b64_tr_b16 v[226:227], v241 offset:8704
    buffer_load_dwordx4 v[16:19], v160, s[20:23], s52 offen offset:0 sc1
    v_mul_f32 v198, v194, v198
    v_mul_f32 v199, v195, v199
    v_mul_f32 v196, v196, v192
    v_mul_f32 v197, v197, v193
    v_mfma_f32_32x32x16_bf16 v[208:223], v[228:231], v[92:95], v[208:223]
    s_waitcnt lgkmcnt(6)
    ds_read_b64_tr_b16 v[228:229], v242 offset:53248
    ds_read_b64_tr_b16 v[230:231], v242 offset:53760
    v_exp_f32 v194, v250
    v_exp_f32 v195, v251
    v_mfma_f32_32x32x16_bf16 v[208:223], v[232:235], v[96:99], v[208:223]
    s_waitcnt lgkmcnt(6)
    ds_read_b64_tr_b16 v[232:233], v242 offset:57344
    ds_read_b64_tr_b16 v[234:235], v242 offset:57856
    v_mul_f32 v250, v200, v200
    v_mul_f32 v251, v201, v201
    v_fma_f32 v194, v194, v247, v247
    v_fma_f32 v195, v195, v247, v247
    v_mfma_f32_32x32x16_bf16 v[208:223], v[236:239], v[100:103], v[208:223]
    s_waitcnt lgkmcnt(6)
    ds_read_b64_tr_b16 v[236:237], v242 offset:61440
    ds_read_b64_tr_b16 v[238:239], v242 offset:61952
    v_fma_f32 v250, v250, v246, v245
    v_fma_f32 v251, v251, v246, v245
    v_rcp_f32 v194, v194
    v_add_u32 v242, 32768, v242
    v_mfma_f32_32x32x16_bf16 v[208:223], v[252:255], v[104:107], v[208:223]
    s_waitcnt lgkmcnt(6)
    ds_read_b64_tr_b16 v[252:253], v242 offset:32768
    ds_read_b64_tr_b16 v[254:255], v242 offset:33280
    buffer_load_dwordx4 v[20:23], v160, s[20:23], s52 offen offset:1024 sc1
    s_mov_b32 s56, s52
    s_add_u32 s52, s52, 4096
    s_and_b32 s52, s52, 0xffff
    v_rcp_f32 v195, v195
    v_mul_f32 v250, v250, v200
    v_mul_f32 v251, v251, v201
    v_mfma_f32_32x32x16_bf16 v[208:223], v[224:227], v[108:111], v[208:223]
    s_waitcnt lgkmcnt(6)
    ds_read_b64_tr_b16 v[224:225], v242 offset:40960
    ds_read_b64_tr_b16 v[226:227], v242 offset:41472
    v_mul_f32 v204, v200, v204
    v_mul_f32 v205, v201, v205
    v_mul_f32 v198, v198, v194
    v_mul_f32 v199, v199, v195
    v_mfma_f32_32x32x16_bf16 v[112:127], v[228:231], v[56:59], v[112:127]
    s_waitcnt lgkmcnt(6)
    ds_read_b64_tr_b16 v[228:229], v242 offset:45056
    ds_read_b64_tr_b16 v[230:231], v242 offset:45568
    v_exp_f32 v200, v250
    v_exp_f32 v201, v251
    v_mfma_f32_32x32x16_bf16 v[112:127], v[232:235], v[60:63], v[112:127]
    s_waitcnt lgkmcnt(6)
    ds_read_b64_tr_b16 v[232:233], v242 offset:49152
    ds_read_b64_tr_b16 v[234:235], v242 offset:49664
    v_mul_f32 v250, v202, v202
    v_mul_f32 v251, v203, v203
    v_fma_f32 v200, v200, v247, v247
    v_fma_f32 v201, v201, v247, v247
    v_mfma_f32_32x32x16_bf16 v[112:127], v[236:239], v[64:67], v[112:127]
    s_waitcnt lgkmcnt(6)
    ds_read_b64_tr_b16 v[236:237], v242 offset:53248
    ds_read_b64_tr_b16 v[238:239], v242 offset:53760
    buffer_load_dwordx4 v[24:27], v160, s[20:23], s56 offen offset:2048 sc1
    v_fma_f32 v250, v250, v246, v245
    v_fma_f32 v251, v251, v246, v245
    v_rcp_f32 v200, v200
    v_mfma_f32_32x32x16_bf16 v[112:127], v[252:255], v[68:71], v[112:127]
    s_waitcnt lgkmcnt(6)
    ds_read_b64_tr_b16 v[252:253], v242 offset:61440
    ds_read_b64_tr_b16 v[254:255], v242 offset:61952
    v_rcp_f32 v201, v201
    v_mul_f32 v250, v250, v202
    v_mul_f32 v251, v251, v203
    v_mfma_f32_32x32x16_bf16 v[112:127], v[224:227], v[72:75], v[112:127]
    s_waitcnt lgkmcnt(6)
    ds_read_b64_tr_b16 v[224:225], v242 offset:36864
    ds_read_b64_tr_b16 v[226:227], v242 offset:37376
    v_mul_f32 v206, v202, v206
    v_mul_f32 v207, v203, v207
    v_mul_f32 v204, v204, v200
    v_mul_f32 v205, v205, v201
    v_mfma_f32_32x32x16_bf16 v[112:127], v[228:231], v[76:79], v[112:127]
    s_waitcnt lgkmcnt(6)
    ds_read_b64_tr_b16 v[228:229], v242 offset:57344
    ds_read_b64_tr_b16 v[230:231], v242 offset:57856
    v_exp_f32 v202, v250
    v_exp_f32 v203, v251
    v_add_u32 v242, -32768, v242
    v_mfma_f32_32x32x16_bf16 v[112:127], v[232:235], v[80:83], v[112:127]
    s_waitcnt lgkmcnt(6)
    ds_read_b64_tr_b16 v[232:233], v242 offset:0
    ds_read_b64_tr_b16 v[234:235], v242 offset:512
    buffer_load_dwordx4 v[28:31], v160, s[20:23], s56 offen offset:3072 sc1
    v_cvt_pk_bf16_f32 v192, v196, v197
    v_cvt_pk_bf16_f32 v193, v198, v199
    v_fma_f32 v202, v202, v247, v247
    v_fma_f32 v203, v203, v247, v247
    v_mfma_f32_32x32x16_bf16 v[112:127], v[236:239], v[84:87], v[112:127]
    s_waitcnt lgkmcnt(6)
    ds_read_b64_tr_b16 v[236:237], v242 offset:4096
    ds_read_b64_tr_b16 v[238:239], v242 offset:4608
    v_cvt_pk_bf16_f32 v194, v204, v205
    v_rcp_f32 v202, v202
    v_rcp_f32 v203, v203
    v_mfma_f32_32x32x16_bf16 v[112:127], v[252:255], v[88:91], v[112:127]
    s_waitcnt lgkmcnt(6)
    ds_read_b64_tr_b16 v[252:253], v242 offset:8192
    ds_read_b64_tr_b16 v[254:255], v242 offset:8704
    v_mul_f32 v206, v206, v202
    v_mul_f32 v207, v207, v203
    v_cvt_pk_bf16_f32 v195, v206, v207
    v_mfma_f32_32x32x16_bf16 v[112:127], v[224:227], v[92:95], v[112:127]
    s_waitcnt lgkmcnt(6)
    ds_read_b64_tr_b16 v[224:225], v243 offset:53248
    ds_read_b64_tr_b16 v[226:227], v243 offset:53760
    buffer_store_dwordx4 v[192:195], v244, s[20:23], s51 offen offset:0 sc1
    v_mul_f32 v250, v208, v208
    v_mul_f32 v251, v209, v209
    v_fma_f32 v250, v250, v246, v245
    v_mfma_f32_32x32x16_bf16 v[112:127], v[228:231], v[96:99], v[112:127]
    s_waitcnt lgkmcnt(6)
    ds_read_b64_tr_b16 v[228:229], v243 offset:57344
    ds_read_b64_tr_b16 v[230:231], v243 offset:57856
    v_fma_f32 v251, v251, v246, v245
    v_mul_f32 v250, v250, v208
    v_mul_f32 v251, v251, v209
    v_mul_f32 v212, v208, v212
    v_mfma_f32_32x32x16_bf16 v[112:127], v[232:235], v[100:103], v[112:127]
    s_waitcnt lgkmcnt(6)
    ds_read_b64_tr_b16 v[232:233], v243 offset:61440
    ds_read_b64_tr_b16 v[234:235], v243 offset:61952
    v_mul_f32 v213, v209, v213
    v_exp_f32 v208, v250
    v_add_u32 v243, 32768, v243
    v_mfma_f32_32x32x16_bf16 v[112:127], v[236:239], v[104:107], v[112:127]
    s_waitcnt lgkmcnt(6)
    ds_read_b64_tr_b16 v[236:237], v243 offset:32768
    ds_read_b64_tr_b16 v[238:239], v243 offset:33280
    v_exp_f32 v209, v251
    v_mul_f32 v250, v210, v210
    v_mul_f32 v251, v211, v211
    v_mfma_f32_32x32x16_bf16 v[112:127], v[252:255], v[108:111], v[112:127]
    s_waitcnt lgkmcnt(6)
    ds_read_b64_tr_b16 v[252:253], v243 offset:40960
    ds_read_b64_tr_b16 v[254:255], v243 offset:41472
    v_fma_f32 v208, v208, v247, v247
    v_fma_f32 v209, v209, v247, v247
    v_fma_f32 v250, v250, v246, v245
    v_fma_f32 v251, v251, v246, v245
    v_mfma_f32_32x32x16_bf16 v[128:143], v[224:227], v[56:59], v[128:143]
    s_waitcnt lgkmcnt(6)
    ds_read_b64_tr_b16 v[224:225], v243 offset:45056
    ds_read_b64_tr_b16 v[226:227], v243 offset:45568
    ds_read_b64_tr_b16 v[56:57], v243 offset:49152
    ds_read_b64_tr_b16 v[58:59], v243 offset:49664
    v_rcp_f32 v208, v208
    v_rcp_f32 v209, v209
    v_mfma_f32_32x32x16_bf16 v[128:143], v[228:231], v[60:63], v[128:143]
    s_waitcnt lgkmcnt(8)
    ds_read_b64_tr_b16 v[228:229], v243 offset:53248
    ds_read_b64_tr_b16 v[230:231], v243 offset:53760
    v_mul_f32 v250, v250, v210
    v_mul_f32 v251, v251, v211
    v_mul_f32 v214, v210, v214
    v_mul_f32 v215, v211, v215
    v_mfma_f32_32x32x16_bf16 v[128:143], v[232:235], v[64:67], v[128:143]
    s_waitcnt lgkmcnt(8)
    ds_read_b64_tr_b16 v[232:233], v243 offset:61440
    ds_read_b64_tr_b16 v[234:235], v243 offset:61952
    v_mul_f32 v212, v212, v208
    v_mul_f32 v213, v213, v209
    v_exp_f32 v210, v250
    v_mfma_f32_32x32x16_bf16 v[128:143], v[236:239], v[68:71], v[128:143]
    s_waitcnt lgkmcnt(8)
    ds_read_b64_tr_b16 v[236:237], v243 offset:36864
    ds_read_b64_tr_b16 v[238:239], v243 offset:37376
    v_exp_f32 v211, v251
    v_mul_f32 v250, v216, v216
    v_mul_f32 v251, v217, v217
    v_mfma_f32_32x32x16_bf16 v[128:143], v[252:255], v[72:75], v[128:143]
    s_waitcnt lgkmcnt(8)
    ds_read_b64_tr_b16 v[252:253], v243 offset:57344
    ds_read_b64_tr_b16 v[254:255], v243 offset:57856
    v_fma_f32 v210, v210, v247, v247
    v_fma_f32 v211, v211, v247, v247
    v_fma_f32 v250, v250, v246, v245
    v_add_u32 v243, -32768, v243
    v_mfma_f32_32x32x16_bf16 v[128:143], v[224:227], v[76:79], v[128:143]
    s_waitcnt lgkmcnt(8)
    ds_read_b64_tr_b16 v[224:225], v243 offset:0
    ds_read_b64_tr_b16 v[226:227], v243 offset:512
    ds_read_b128 v[64:67], v161 offset:0
    v_fma_f32 v251, v251, v246, v245
    v_rcp_f32 v210, v210
    v_rcp_f32 v211, v211
    v_mfma_f32_32x32x16_bf16 v[128:143], v[56:59], v[80:83], v[128:143]
    s_waitcnt lgkmcnt(9)
    ds_read_b64_tr_b16 v[56:57], v243 offset:4096
    ds_read_b64_tr_b16 v[58:59], v243 offset:4608
    ds_read_b128 v[68:71], v161 offset:1024
    v_mul_f32 v250, v250, v216
    v_mul_f32 v251, v251, v217
    v_mul_f32 v220, v216, v220
    v_mul_f32 v221, v217, v221
    v_mfma_f32_32x32x16_bf16 v[128:143], v[228:231], v[84:87], v[128:143]
    s_waitcnt lgkmcnt(10)
    ds_read_b64_tr_b16 v[228:229], v243 offset:8192
    ds_read_b64_tr_b16 v[230:231], v243 offset:8704
    ds_read_b128 v[72:75], v162 offset:0
    v_mul_f32 v214, v214, v210
    v_mul_f32 v215, v215, v211
    v_exp_f32 v216, v250
    v_mfma_f32_32x32x16_bf16 v[128:143], v[232:235], v[88:91], v[128:143]
    s_waitcnt lgkmcnt(11)
    ds_read_b128 v[76:79], v162 offset:1024
    v_exp_f32 v217, v251
    v_mul_f32 v250, v218, v218
    v_mul_f32 v251, v219, v219
    v_fma_f32 v216, v216, v247, v247
    v_mfma_f32_32x32x16_bf16 v[128:143], v[236:239], v[92:95], v[128:143]
    s_waitcnt lgkmcnt(10)
    ds_read_b128 v[80:83], v163 offset:0
    v_fma_f32 v217, v217, v247, v247
    v_fma_f32 v250, v250, v246, v245
    v_fma_f32 v251, v251, v246, v245
    v_rcp_f32 v216, v216
    v_mfma_f32_32x32x16_bf16 v[128:143], v[252:255], v[96:99], v[128:143]
    s_waitcnt lgkmcnt(9)
    ds_read_b128 v[84:87], v163 offset:1024
    v_rcp_f32 v217, v217
    v_mul_f32 v250, v250, v218
    v_mul_f32 v251, v251, v219
    v_mul_f32 v222, v218, v222
    v_mfma_f32_32x32x16_bf16 v[128:143], v[224:227], v[100:103], v[128:143]
    s_waitcnt lgkmcnt(7)
    ds_read_b128 v[88:91], v164 offset:0
    v_mul_f32 v223, v219, v223
    v_mul_f32 v220, v220, v216
    v_mul_f32 v221, v221, v217
    v_exp_f32 v218, v250
    v_mfma_f32_32x32x16_bf16 v[128:143], v[56:59], v[104:107], v[128:143]
    s_waitcnt lgkmcnt(5)
    ds_read_b128 v[92:95], v164 offset:1024
    v_exp_f32 v219, v251
    v_cvt_pk_bf16_f32 v208, v212, v213
    v_cvt_pk_bf16_f32 v209, v214, v215
    v_fma_f32 v218, v218, v247, v247
    v_mfma_f32_32x32x16_bf16 v[128:143], v[228:231], v[108:111], v[128:143]
    v_fma_f32 v219, v219, v247, v247
    v_cvt_pk_bf16_f32 v210, v220, v221
    v_rcp_f32 v218, v218
    v_rcp_f32 v219, v219
    s_nop 0
    v_mul_f32 v222, v222, v218
    v_mul_f32 v223, v223, v219
    v_cvt_pk_bf16_f32 v211, v222, v223
    buffer_store_dwordx4 v[208:211], v244, s[20:23], s51 offen offset:1024 sc1
    v_mul_f32 v250, v112, v112
    v_mul_f32 v251, v113, v113
    v_fma_f32 v250, v250, v246, v245
    v_fma_f32 v251, v251, v246, v245
    v_mul_f32 v250, v250, v112
    v_mul_f32 v251, v251, v113
    v_mul_f32 v116, v112, v116
    v_mul_f32 v117, v113, v117
    v_exp_f32 v112, v250
    v_exp_f32 v113, v251
    v_mul_f32 v250, v114, v114
    v_mul_f32 v251, v115, v115
    v_fma_f32 v112, v112, v247, v247
    v_fma_f32 v113, v113, v247, v247
    v_fma_f32 v250, v250, v246, v245
    v_fma_f32 v251, v251, v246, v245
    v_rcp_f32 v112, v112
    v_rcp_f32 v113, v113
    v_mul_f32 v250, v250, v114
    v_mul_f32 v251, v251, v115
    v_mul_f32 v118, v114, v118
    v_mul_f32 v119, v115, v119
    v_mul_f32 v116, v116, v112
    v_mul_f32 v117, v117, v113
    v_exp_f32 v114, v250
    v_exp_f32 v115, v251
    v_mul_f32 v250, v120, v120
    v_mul_f32 v251, v121, v121
    v_fma_f32 v114, v114, v247, v247
    v_fma_f32 v115, v115, v247, v247
    v_fma_f32 v250, v250, v246, v245
    v_fma_f32 v251, v251, v246, v245
    v_rcp_f32 v114, v114
    v_rcp_f32 v115, v115
    v_mul_f32 v250, v250, v120
    v_mul_f32 v251, v251, v121
    v_mul_f32 v124, v120, v124
    v_mul_f32 v125, v121, v125
    v_mul_f32 v118, v118, v114
    v_mul_f32 v119, v119, v115
    v_exp_f32 v120, v250
    v_exp_f32 v121, v251
    v_mul_f32 v250, v122, v122
    v_mul_f32 v251, v123, v123
    v_fma_f32 v120, v120, v247, v247
    v_fma_f32 v121, v121, v247, v247
    v_fma_f32 v250, v250, v246, v245
    v_fma_f32 v251, v251, v246, v245
    v_rcp_f32 v120, v120
    v_rcp_f32 v121, v121
    v_mul_f32 v250, v250, v122
    v_mul_f32 v251, v251, v123
    v_mul_f32 v126, v122, v126
    v_mul_f32 v127, v123, v127
    v_mul_f32 v124, v124, v120
    v_mul_f32 v125, v125, v121
    v_exp_f32 v122, v250
    v_exp_f32 v123, v251
    v_cvt_pk_bf16_f32 v112, v116, v117
    v_cvt_pk_bf16_f32 v113, v118, v119
    v_fma_f32 v122, v122, v247, v247
    v_fma_f32 v123, v123, v247, v247
    v_cvt_pk_bf16_f32 v114, v124, v125
    v_rcp_f32 v122, v122
    v_rcp_f32 v123, v123
    s_nop 0
    v_mul_f32 v126, v126, v122
    v_mul_f32 v127, v127, v123
    v_cvt_pk_bf16_f32 v115, v126, v127
    buffer_store_dwordx4 v[112:115], v244, s[20:23], s51 offen offset:2048 sc1
    v_mul_f32 v250, v128, v128
    v_mul_f32 v251, v129, v129
    v_fma_f32 v250, v250, v246, v245
    v_fma_f32 v251, v251, v246, v245
    v_mul_f32 v250, v250, v128
    v_mul_f32 v251, v251, v129
    v_mul_f32 v132, v128, v132
    v_mul_f32 v133, v129, v133
    v_mov_b32 v224, 0
    v_mov_b32 v225, 0
    v_mov_b32 v226, 0
    v_mov_b32 v227, 0
    s_lshl_b32 s53, s43, 16
    v_add_u32 v241, s53, v244
    v_mov_b32 v240, 0xdddddddd
    v_lshrrev_b32 v255, 4, v244
    v_exp_f32 v128, v250
    v_exp_f32 v129, v251
    v_mul_f32 v250, v130, v130
    v_mul_f32 v251, v131, v131
    v_fma_f32 v128, v128, v247, v247
    v_fma_f32 v129, v129, v247, v247
    v_fma_f32 v250, v250, v246, v245
    v_mfma_f32_32x32x16_bf16 v[144:159], v[224:227], v[224:227], 0
    v_fma_f32 v251, v251, v246, v245
    v_rcp_f32 v128, v128
    v_rcp_f32 v129, v129
    v_mul_f32 v250, v250, v130
    v_mul_f32 v251, v251, v131
    v_mul_f32 v134, v130, v134
    v_mul_f32 v135, v131, v135
    v_mfma_f32_32x32x16_bf16 v[160:175], v[224:227], v[224:227], 0
    v_mul_f32 v132, v132, v128
    v_mul_f32 v133, v133, v129
    v_exp_f32 v130, v250
    v_exp_f32 v131, v251
    v_mul_f32 v250, v136, v136
    v_mul_f32 v251, v137, v137
    v_fma_f32 v130, v130, v247, v247
    v_mfma_f32_32x32x16_bf16 v[176:191], v[224:227], v[224:227], 0
    v_fma_f32 v131, v131, v247, v247
    v_fma_f32 v250, v250, v246, v245
    v_fma_f32 v251, v251, v246, v245
    v_rcp_f32 v130, v130
    v_rcp_f32 v131, v131
    v_mul_f32 v250, v250, v136
    v_mul_f32 v251, v251, v137
    v_mfma_f32_32x32x16_bf16 v[96:111], v[224:227], v[224:227], 0
    v_mul_f32 v140, v136, v140
    v_mul_f32 v141, v137, v141
    v_mul_f32 v134, v134, v130
    v_mul_f32 v135, v135, v131
    v_exp_f32 v136, v250
    v_exp_f32 v137, v251
    v_mul_f32 v250, v138, v138
    s_waitcnt lgkmcnt(0)
    s_waitcnt vmcnt(9)
    v_mfma_f32_32x32x16_bf16 v[192:207], v[0:3], v[64:67], 0
    v_mul_f32 v251, v139, v139
    v_fma_f32 v136, v136, v247, v247
    v_fma_f32 v137, v137, v247, v247
    v_fma_f32 v250, v250, v246, v245
    v_fma_f32 v251, v251, v246, v245
    v_rcp_f32 v136, v136
    v_rcp_f32 v137, v137
    v_mfma_f32_32x32x16_bf16 v[192:207], v[4:7], v[68:71], v[192:207]
    v_mul_f32 v250, v250, v138
    v_mul_f32 v251, v251, v139
    v_mul_f32 v142, v138, v142
    v_mul_f32 v143, v139, v143
    v_mul_f32 v140, v140, v136
    v_mul_f32 v141, v141, v137
    v_exp_f32 v138, v250
    v_exp_f32 v139, v251
    v_cvt_pk_bf16_f32 v128, v132, v133
    v_cvt_pk_bf16_f32 v129, v134, v135
    v_fma_f32 v138, v138, v247, v247
    v_fma_f32 v139, v139, v247, v247
    v_cvt_pk_bf16_f32 v130, v140, v141
    v_rcp_f32 v138, v138
    v_rcp_f32 v139, v139
    s_nop 0
    v_mul_f32 v142, v142, v138
    v_mul_f32 v143, v143, v139
    v_cvt_pk_bf16_f32 v131, v142, v143
    buffer_store_dwordx4 v[128:131], v244, s[20:23], s51 offen offset:3072 sc1
L_att0:
    v_mfma_f32_32x32x16_bf16 v[208:223], v[0:3], v[72:75], 0
    buffer_load_dwordx4 v[32:35], v241, s[20:23], s52 offen offset:0 sc1
    v_exp_f32 v192, v192
    v_exp_f32 v193, v193
    v_exp_f32 v194, v194
    v_exp_f32 v195, v195
    v_mfma_f32_32x32x16_bf16 v[208:223], v[4:7], v[76:79], v[208:223]
    buffer_load_dwordx4 v[36:39], v241, s[20:23], s52 offen offset:1024 sc1
    s_mov_b32 s56, s52
    s_add_u32 s52, s52, 4096
    s_and_b32 s52, s52, 0xffff
    v_exp_f32 v196, v196
    v_exp_f32 v197, v197
    v_exp_f32 v198, v198
    v_exp_f32 v199, v199
    buffer_load_dwordx4 v[40:43], v241, s[20:23], s56 offen offset:2048 sc1
    v_exp_f32 v200, v200
    v_exp_f32 v201, v201
    v_exp_f32 v202, v202
    v_exp_f32 v203, v203
    s_waitcnt vmcnt(11)
    v_smfmac_f32_32x32x32_bf16 v[144:159], v[8:11], v[192:199], v240
    v_exp_f32 v204, v204
    v_exp_f32 v205, v205
    v_exp_f32 v206, v206
    v_exp_f32 v207, v207
    v_mfma_f32_32x32x16_bf16 v[112:127], v[0:3], v[80:83], 0
    buffer_load_dwordx4 v[44:47], v241, s[20:23], s56 offen offset:3072 sc1
    v_exp_f32 v208, v208
    v_exp_f32 v209, v209
    v_exp_f32 v210, v210
    v_exp_f32 v211, v211
    v_mfma_f32_32x32x16_bf16 v[112:127], v[4:7], v[84:87], v[112:127]
    buffer_load_dwordx4 v[48:51], v241, s[20:23], s52 offen offset:0 sc1
    v_exp_f32 v212, v212
    v_exp_f32 v213, v213
    v_exp_f32 v214, v214
    v_exp_f32 v215, v215
    v_smfmac_f32_32x32x32_bf16 v[144:159], v[12:15], v[200:207], v240
    buffer_load_dwordx4 v[52:55], v241, s[20:23], s52 offen offset:1024 sc1
    s_mov_b32 s56, s52
    s_add_u32 s52, s52, 4096
    s_and_b32 s52, s52, 0xffff
    v_exp_f32 v216, v216
    v_exp_f32 v217, v217
    v_exp_f32 v218, v218
    v_exp_f32 v219, v219
    v_smfmac_f32_32x32x32_bf16 v[160:175], v[8:11], v[208:215], v240
    v_exp_f32 v220, v220
    v_exp_f32 v221, v221
    v_exp_f32 v222, v222
    v_exp_f32 v223, v223
    v_mfma_f32_32x32x16_bf16 v[128:143], v[0:3], v[88:91], 0
    buffer_load_dwordx4 v[56:59], v241, s[20:23], s56 offen offset:2048 sc1
    v_exp_f32 v112, v112
    v_exp_f32 v113, v113
    v_exp_f32 v114, v114
    v_exp_f32 v115, v115
    v_mfma_f32_32x32x16_bf16 v[128:143], v[4:7], v[92:95], v[128:143]
    buffer_load_dwordx4 v[60:63], v241, s[20:23], s56 offen offset:3072 sc1
    v_exp_f32 v116, v116
    v_exp_f32 v117, v117
    v_exp_f32 v118, v118
    v_exp_f32 v119, v119
    v_smfmac_f32_32x32x32_bf16 v[160:175], v[12:15], v[216:223], v240
    v_exp_f32 v120, v120
    v_exp_f32 v121, v121
    v_exp_f32 v122, v122
    v_exp_f32 v123, v123
    v_smfmac_f32_32x32x32_bf16 v[176:191], v[8:11], v[112:119], v240
    v_exp_f32 v124, v124
    v_exp_f32 v125, v125
    v_exp_f32 v126, v126
    v_exp_f32 v127, v127
    s_waitcnt vmcnt(14)
    v_mfma_f32_32x32x16_bf16 v[192:207], v[16:19], v[64:67], 0
    buffer_load_dwordx4 v[0:3], v241, s[20:23], s52 offen offset:0 sc1
    v_exp_f32 v128, v128
    v_exp_f32 v129, v129
    v_exp_f32 v130, v130
    v_exp_f32 v131, v131
    v_mfma_f32_32x32x16_bf16 v[192:207], v[20:23], v[68:71], v[192:207]
    buffer_load_dwordx4 v[4:7], v241, s[20:23], s52 offen offset:1024 sc1
    s_mov_b32 s56, s52
    s_add_u32 s52, s52, 4096
    s_and_b32 s52, s52, 0xffff
    v_exp_f32 v132, v132
    v_exp_f32 v133, v133
    v_exp_f32 v134, v134
    v_exp_f32 v135, v135
    v_smfmac_f32_32x32x32_bf16 v[176:191], v[12:15], v[120:127], v240
    v_exp_f32 v136, v136
    v_exp_f32 v137, v137
    v_exp_f32 v138, v138
    v_exp_f32 v139, v139
    v_smfmac_f32_32x32x32_bf16 v[96:111], v[8:11], v[128:135], v240
    v_exp_f32 v140, v140
    v_exp_f32 v141, v141
    v_exp_f32 v142, v142
    v_exp_f32 v143, v143
    v_mfma_f32_32x32x16_bf16 v[208:223], v[16:19], v[72:75], 0
    v_exp_f32 v192, v192
    v_exp_f32 v193, v193
    v_exp_f32 v194, v194
    v_exp_f32 v195, v195
    v_mfma_f32_32x32x16_bf16 v[208:223], v[20:23], v[76:79], v[208:223]
    v_exp_f32 v196, v196
    v_exp_f32 v197, v197
    v_exp_f32 v198, v198
    v_exp_f32 v199, v199
    v_smfmac_f32_32x32x32_bf16 v[96:111], v[12:15], v[136:143], v240
    v_exp_f32 v200, v200
    v_exp_f32 v201, v201
    v_exp_f32 v202, v202
    v_exp_f32 v203, v203
    s_waitcnt vmcnt(14)
    v_smfmac_f32_32x32x32_bf16 v[144:159], v[24:27], v[192:199], v240
    v_exp_f32 v204, v204
    v_exp_f32 v205, v205
    v_exp_f32 v206, v206
    v_exp_f32 v207, v207
    v_mfma_f32_32x32x16_bf16 v[112:127], v[16:19], v[80:83], 0
    buffer_load_dwordx4 v[8:11], v241, s[20:23], s56 offen offset:2048 sc1
    v_exp_f32 v208, v208
    v_exp_f32 v209, v209
    v_exp_f32 v210, v210
    v_exp_f32 v211, v211
    v_mfma_f32_32x32x16_bf16 v[112:127], v[20:23], v[84:87], v[112:127]
    v_exp_f32 v212, v212
    v_exp_f32 v213, v213
    v_exp_f32 v214, v214
    v_exp_f32 v215, v215
    v_smfmac_f32_32x32x32_bf16 v[144:159], v[28:31], v[200:207], v240
    v_exp_f32 v216, v216
    v_exp_f32 v217, v217
    v_exp_f32 v218, v218
    v_exp_f32 v219, v219
    v_smfmac_f32_32x32x32_bf16 v[160:175], v[24:27], v[208:215], v240
    v_exp_f32 v220, v220
    v_exp_f32 v221, v221
    v_exp_f32 v222, v222
    v_exp_f32 v223, v223
    v_mfma_f32_32x32x16_bf16 v[128:143], v[16:19], v[88:91], 0
    buffer_load_dwordx4 v[12:15], v241, s[20:23], s56 offen offset:3072 sc1
    v_exp_f32 v112, v112
    v_exp_f32 v113, v113
    v_exp_f32 v114, v114
    v_exp_f32 v115, v115
    v_mfma_f32_32x32x16_bf16 v[128:143], v[20:23], v[92:95], v[128:143]
    v_exp_f32 v116, v116
    v_exp_f32 v117, v117
    v_exp_f32 v118, v118
    v_exp_f32 v119, v119
    v_smfmac_f32_32x32x32_bf16 v[160:175], v[28:31], v[216:223], v240
    v_exp_f32 v120, v120
    v_exp_f32 v121, v121
    v_exp_f32 v122, v122
    v_exp_f32 v123, v123
    v_smfmac_f32_32x32x32_bf16 v[176:191], v[24:27], v[112:119], v240
    v_exp_f32 v124, v124
    v_exp_f32 v125, v125
    v_exp_f32 v126, v126
    v_exp_f32 v127, v127
    s_waitcnt vmcnt(10)
    v_mfma_f32_32x32x16_bf16 v[192:207], v[32:35], v[64:67], 0
    s_barrier
    buffer_load_dwordx4 v[16:19], v241, s[20:23], s52 offen offset:0 sc1
    v_exp_f32 v128, v128
    v_exp_f32 v129, v129
    v_exp_f32 v130, v130
    v_exp_f32 v131, v131
    v_mfma_f32_32x32x16_bf16 v[192:207], v[36:39], v[68:71], v[192:207]
    v_exp_f32 v132, v132
    v_exp_f32 v133, v133
    v_exp_f32 v134, v134
    v_exp_f32 v135, v135
    v_smfmac_f32_32x32x32_bf16 v[176:191], v[28:31], v[120:127], v240
    v_exp_f32 v136, v136
    v_exp_f32 v137, v137
    v_exp_f32 v138, v138
    v_exp_f32 v139, v139
    v_smfmac_f32_32x32x32_bf16 v[96:111], v[24:27], v[128:135], v240
    v_exp_f32 v140, v140
    v_exp_f32 v141, v141
    v_exp_f32 v142, v142
    v_exp_f32 v143, v143
    v_mfma_f32_32x32x16_bf16 v[208:223], v[32:35], v[72:75], 0
    buffer_load_dwordx4 v[20:23], v241, s[20:23], s52 offen offset:1024 sc1
    s_mov_b32 s56, s52
    s_add_u32 s52, s52, 4096
    s_and_b32 s52, s52, 0xffff
    v_exp_f32 v192, v192
    v_exp_f32 v193, v193
    v_exp_f32 v194, v194
    v_exp_f32 v195, v195
    v_mfma_f32_32x32x16_bf16 v[208:223], v[36:39], v[76:79], v[208:223]
    v_exp_f32 v196, v196
    v_exp_f32 v197, v197
    v_exp_f32 v198, v198
    v_exp_f32 v199, v199
    v_smfmac_f32_32x32x32_bf16 v[96:111], v[28:31], v[136:143], v240
    v_exp_f32 v200, v200
    v_exp_f32 v201, v201
    v_exp_f32 v202, v202
    v_exp_f32 v203, v203
    s_waitcnt vmcnt(10)
    v_smfmac_f32_32x32x32_bf16 v[144:159], v[40:43], v[192:199], v240
    v_exp_f32 v204, v204
    v_exp_f32 v205, v205
    v_exp_f32 v206, v206
    v_exp_f32 v207, v207
    v_mfma_f32_32x32x16_bf16 v[112:127], v[32:35], v[80:83], 0
    buffer_load_dwordx4 v[24:27], v241, s[20:23], s56 offen offset:2048 sc1
    v_exp_f32 v208, v208
    v_exp_f32 v209, v209
    v_exp_f32 v210, v210
    v_exp_f32 v211, v211
    v_mfma_f32_32x32x16_bf16 v[112:127], v[36:39], v[84:87], v[112:127]
    v_exp_f32 v212, v212
    v_exp_f32 v213, v213
    v_exp_f32 v214, v214
    v_exp_f32 v215, v215
    v_smfmac_f32_32x32x32_bf16 v[144:159], v[44:47], v[200:207], v240
    v_exp_f32 v216, v216
    v_exp_f32 v217, v217
    v_exp_f32 v218, v218
    v_exp_f32 v219, v219
    v_smfmac_f32_32x32x32_bf16 v[160:175], v[40:43], v[208:215], v240
    v_exp_f32 v220, v220
    v_exp_f32 v221, v221
    v_exp_f32 v222, v222
    v_exp_f32 v223, v223
    v_mfma_f32_32x32x16_bf16 v[128:143], v[32:35], v[88:91], 0
    buffer_load_dwordx4 v[28:31], v241, s[20:23], s56 offen offset:3072 sc1
    v_exp_f32 v112, v112
    v_exp_f32 v113, v113
    v_exp_f32 v114, v114
    v_exp_f32 v115, v115
    v_mfma_f32_32x32x16_bf16 v[128:143], v[36:39], v[92:95], v[128:143]
    v_exp_f32 v116, v116
    v_exp_f32 v117, v117
    v_exp_f32 v118, v118
    v_exp_f32 v119, v119
    v_smfmac_f32_32x32x32_bf16 v[160:175], v[44:47], v[216:223], v240
    v_exp_f32 v120, v120
    v_exp_f32 v121, v121
    v_exp_f32 v122, v122
    v_exp_f32 v123, v123
    v_smfmac_f32_32x32x32_bf16 v[176:191], v[40:43], v[112:119], v240
    v_exp_f32 v124, v124
    v_exp_f32 v125, v125
    v_exp_f32 v126, v126
    v_exp_f32 v127, v127
    s_waitcnt vmcnt(10)
    v_mfma_f32_32x32x16_bf16 v[192:207], v[48:51], v[64:67], 0
    buffer_load_dwordx4 v[32:35], v241, s[20:23], s52 offen offset:0 sc1
    v_exp_f32 v128, v128
    v_exp_f32 v129, v129
    v_exp_f32 v130, v130
    v_exp_f32 v131, v131
    v_mfma_f32_32x32x16_bf16 v[192:207], v[52:55], v[68:71], v[192:207]
    v_exp_f32 v132, v132
    v_exp_f32 v133, v133
    v_exp_f32 v134, v134
    v_exp_f32 v135, v135
    v_smfmac_f32_32x32x32_bf16 v[176:191], v[44:47], v[120:127], v240
    v_exp_f32 v136, v136
    v_exp_f32 v137, v137
    v_exp_f32 v138, v138
    v_exp_f32 v139, v139
    v_smfmac_f32_32x32x32_bf16 v[96:111], v[40:43], v[128:135], v240
    v_exp_f32 v140, v140
    v_exp_f32 v141, v141
    v_exp_f32 v142, v142
    v_exp_f32 v143, v143
    v_mfma_f32_32x32x16_bf16 v[208:223], v[48:51], v[72:75], 0
    buffer_load_dwordx4 v[36:39], v241, s[20:23], s52 offen offset:1024 sc1
    s_mov_b32 s56, s52
    s_add_u32 s52, s52, 4096
    s_and_b32 s52, s52, 0xffff
    v_exp_f32 v192, v192
    v_exp_f32 v193, v193
    v_exp_f32 v194, v194
    v_exp_f32 v195, v195
    v_mfma_f32_32x32x16_bf16 v[208:223], v[52:55], v[76:79], v[208:223]
    v_exp_f32 v196, v196
    v_exp_f32 v197, v197
    v_exp_f32 v198, v198
    v_exp_f32 v199, v199
    v_smfmac_f32_32x32x32_bf16 v[96:111], v[44:47], v[136:143], v240
    v_exp_f32 v200, v200
    v_exp_f32 v201, v201
    v_exp_f32 v202, v202
    v_exp_f32 v203, v203
    s_waitcnt vmcnt(10)
    v_smfmac_f32_32x32x32_bf16 v[144:159], v[56:59], v[192:199], v240
    v_exp_f32 v204, v204
    v_exp_f32 v205, v205
    v_exp_f32 v206, v206
    v_exp_f32 v207, v207
    v_mfma_f32_32x32x16_bf16 v[112:127], v[48:51], v[80:83], 0
    buffer_load_dwordx4 v[40:43], v241, s[20:23], s56 offen offset:2048 sc1
    v_exp_f32 v208, v208
    v_exp_f32 v209, v209
    v_exp_f32 v210, v210
    v_exp_f32 v211, v211
    v_mfma_f32_32x32x16_bf16 v[112:127], v[52:55], v[84:87], v[112:127]
    v_exp_f32 v212, v212
    v_exp_f32 v213, v213
    v_exp_f32 v214, v214
    v_exp_f32 v215, v215
    v_smfmac_f32_32x32x32_bf16 v[144:159], v[60:63], v[200:207], v240
    v_exp_f32 v216, v216
    v_exp_f32 v217, v217
    v_exp_f32 v218, v218
    v_exp_f32 v219, v219
    v_smfmac_f32_32x32x32_bf16 v[160:175], v[56:59], v[208:215], v240
    v_exp_f32 v220, v220
    v_exp_f32 v221, v221
    v_exp_f32 v222, v222
    v_exp_f32 v223, v223
    v_mfma_f32_32x32x16_bf16 v[128:143], v[48:51], v[88:91], 0
    buffer_load_dwordx4 v[44:47], v241, s[20:23], s56 offen offset:3072 sc1
    v_exp_f32 v112, v112
    v_exp_f32 v113, v113
    v_exp_f32 v114, v114
    v_exp_f32 v115, v115
    v_mfma_f32_32x32x16_bf16 v[128:143], v[52:55], v[92:95], v[128:143]
    v_exp_f32 v116, v116
    v_exp_f32 v117, v117
    v_exp_f32 v118, v118
    v_exp_f32 v119, v119
    v_smfmac_f32_32x32x32_bf16 v[160:175], v[60:63], v[216:223], v240
    v_exp_f32 v120, v120
    v_exp_f32 v121, v121
    v_exp_f32 v122, v122
    v_exp_f32 v123, v123
    v_smfmac_f32_32x32x32_bf16 v[176:191], v[56:59], v[112:119], v240
    v_exp_f32 v124, v124
    v_exp_f32 v125, v125
    v_exp_f32 v126, v126
    v_exp_f32 v127, v127
    s_waitcnt vmcnt(10)
    v_mfma_f32_32x32x16_bf16 v[192:207], v[0:3], v[64:67], 0
    buffer_load_dwordx4 v[48:51], v241, s[20:23], s52 offen offset:0 sc1
    v_exp_f32 v128, v128
    v_exp_f32 v129, v129
    v_exp_f32 v130, v130
    v_exp_f32 v131, v131
    v_mfma_f32_32x32x16_bf16 v[192:207], v[4:7], v[68:71], v[192:207]
    v_exp_f32 v132, v132
    v_exp_f32 v133, v133
    v_exp_f32 v134, v134
    v_exp_f32 v135, v135
    v_smfmac_f32_32x32x32_bf16 v[176:191], v[60:63], v[120:127], v240
    v_exp_f32 v136, v136
    v_exp_f32 v137, v137
    v_exp_f32 v138, v138
    v_exp_f32 v139, v139
    v_smfmac_f32_32x32x32_bf16 v[96:111], v[56:59], v[128:135], v240
    v_exp_f32 v140, v140
    v_exp_f32 v141, v141
    v_exp_f32 v142, v142
    v_exp_f32 v143, v143
    v_mfma_f32_32x32x16_bf16 v[208:223], v[0:3], v[72:75], 0
    buffer_load_dwordx4 v[52:55], v241, s[20:23], s52 offen offset:1024 sc1
    s_mov_b32 s56, s52
    s_add_u32 s52, s52, 4096
    s_and_b32 s52, s52, 0xffff
    v_exp_f32 v192, v192
    v_exp_f32 v193, v193
    v_exp_f32 v194, v194
    v_exp_f32 v195, v195
    v_mfma_f32_32x32x16_bf16 v[208:223], v[4:7], v[76:79], v[208:223]
    v_exp_f32 v196, v196
    v_exp_f32 v197, v197
    v_exp_f32 v198, v198
    v_exp_f32 v199, v199
    v_smfmac_f32_32x32x32_bf16 v[96:111], v[60:63], v[136:143], v240
    v_exp_f32 v200, v200
    v_exp_f32 v201, v201
    v_exp_f32 v202, v202
    v_exp_f32 v203, v203
    s_waitcnt vmcnt(10)
    v_smfmac_f32_32x32x32_bf16 v[144:159], v[8:11], v[192:199], v240
    v_exp_f32 v204, v204
    v_exp_f32 v205, v205
    v_exp_f32 v206, v206
    v_exp_f32 v207, v207
    v_mfma_f32_32x32x16_bf16 v[112:127], v[0:3], v[80:83], 0
    buffer_load_dwordx4 v[56:59], v241, s[20:23], s56 offen offset:2048 sc1
    v_exp_f32 v208, v208
    v_exp_f32 v209, v209
    v_exp_f32 v210, v210
    v_exp_f32 v211, v211
    v_mfma_f32_32x32x16_bf16 v[112:127], v[4:7], v[84:87], v[112:127]
    v_exp_f32 v212, v212
    v_exp_f32 v213, v213
    v_exp_f32 v214, v214
    v_exp_f32 v215, v215
    v_smfmac_f32_32x32x32_bf16 v[144:159], v[12:15], v[200:207], v240
    v_exp_f32 v216, v216
    v_exp_f32 v217, v217
    v_exp_f32 v218, v218
    v_exp_f32 v219, v219
    v_smfmac_f32_32x32x32_bf16 v[160:175], v[8:11], v[208:215], v240
    v_exp_f32 v220, v220
    v_exp_f32 v221, v221
    v_exp_f32 v222, v222
    v_exp_f32 v223, v223
    v_mfma_f32_32x32x16_bf16 v[128:143], v[0:3], v[88:91], 0
    buffer_load_dwordx4 v[60:63], v241, s[20:23], s56 offen offset:3072 sc1
    v_exp_f32 v112, v112
    v_exp_f32 v113, v113
    v_exp_f32 v114, v114
    v_exp_f32 v115, v115
    v_mfma_f32_32x32x16_bf16 v[128:143], v[4:7], v[92:95], v[128:143]
    v_exp_f32 v116, v116
    v_exp_f32 v117, v117
    v_exp_f32 v118, v118
    v_exp_f32 v119, v119
    v_smfmac_f32_32x32x32_bf16 v[160:175], v[12:15], v[216:223], v240
    v_exp_f32 v120, v120
    v_exp_f32 v121, v121
    v_exp_f32 v122, v122
    v_exp_f32 v123, v123
    v_smfmac_f32_32x32x32_bf16 v[176:191], v[8:11], v[112:119], v240
    v_exp_f32 v124, v124
    v_exp_f32 v125, v125
    v_exp_f32 v126, v126
    v_exp_f32 v127, v127
    s_waitcnt vmcnt(10)
    v_mfma_f32_32x32x16_bf16 v[192:207], v[16:19], v[64:67], 0
    buffer_load_dwordx4 v[0:3], v241, s[20:23], s52 offen offset:0 sc1
    v_exp_f32 v128, v128
    v_exp_f32 v129, v129
    v_exp_f32 v130, v130
    v_exp_f32 v131, v131
    v_mfma_f32_32x32x16_bf16 v[192:207], v[20:23], v[68:71], v[192:207]
    v_exp_f32 v132, v132
    v_exp_f32 v133, v133
    v_exp_f32 v134, v134
    v_exp_f32 v135, v135
    v_smfmac_f32_32x32x32_bf16 v[176:191], v[12:15], v[120:127], v240
    v_exp_f32 v136, v136
    v_exp_f32 v137, v137
    v_exp_f32 v138, v138
    v_exp_f32 v139, v139
    v_smfmac_f32_32x32x32_bf16 v[96:111], v[8:11], v[128:135], v240
    v_exp_f32 v140, v140
    v_exp_f32 v141, v141
    v_exp_f32 v142, v142
    v_exp_f32 v143, v143
    v_mfma_f32_32x32x16_bf16 v[208:223], v[16:19], v[72:75], 0
    buffer_load_dwordx4 v[4:7], v241, s[20:23], s52 offen offset:1024 sc1
    s_mov_b32 s56, s52
    s_add_u32 s52, s52, 4096
    s_and_b32 s52, s52, 0xffff
    v_exp_f32 v192, v192
    v_exp_f32 v193, v193
    v_exp_f32 v194, v194
    v_exp_f32 v195, v195
    v_mfma_f32_32x32x16_bf16 v[208:223], v[20:23], v[76:79], v[208:223]
    v_exp_f32 v196, v196
    v_exp_f32 v197, v197
    v_exp_f32 v198, v198
    v_exp_f32 v199, v199
    v_smfmac_f32_32x32x32_bf16 v[96:111], v[12:15], v[136:143], v240
    v_exp_f32 v200, v200
    v_exp_f32 v201, v201
    v_exp_f32 v202, v202
    v_exp_f32 v203, v203
    s_waitcnt vmcnt(10)
    v_smfmac_f32_32x32x32_bf16 v[144:159], v[24:27], v[192:199], v240
    v_exp_f32 v204, v204
    v_exp_f32 v205, v205
    v_exp_f32 v206, v206
    v_exp_f32 v207, v207
    v_mfma_f32_32x32x16_bf16 v[112:127], v[16:19], v[80:83], 0
    buffer_load_dwordx4 v[8:11], v241, s[20:23], s56 offen offset:2048 sc1
    v_exp_f32 v208, v208
    v_exp_f32 v209, v209
    v_exp_f32 v210, v210
    v_exp_f32 v211, v211
    v_mfma_f32_32x32x16_bf16 v[112:127], v[20:23], v[84:87], v[112:127]
    v_exp_f32 v212, v212
    v_exp_f32 v213, v213
    v_exp_f32 v214, v214
    v_exp_f32 v215, v215
    v_smfmac_f32_32x32x32_bf16 v[144:159], v[28:31], v[200:207], v240
    v_exp_f32 v216, v216
    v_exp_f32 v217, v217
    v_exp_f32 v218, v218
    v_exp_f32 v219, v219
    v_smfmac_f32_32x32x32_bf16 v[160:175], v[24:27], v[208:215], v240
    v_exp_f32 v220, v220
    v_exp_f32 v221, v221
    v_exp_f32 v222, v222
    v_exp_f32 v223, v223
    v_mfma_f32_32x32x16_bf16 v[128:143], v[16:19], v[88:91], 0
    buffer_load_dwordx4 v[12:15], v241, s[20:23], s56 offen offset:3072 sc1
    v_exp_f32 v112, v112
    v_exp_f32 v113, v113
    v_exp_f32 v114, v114
    v_exp_f32 v115, v115
    v_mfma_f32_32x32x16_bf16 v[128:143], v[20:23], v[92:95], v[128:143]
    v_exp_f32 v116, v116
    v_exp_f32 v117, v117
    v_exp_f32 v118, v118
    v_exp_f32 v119, v119
    v_smfmac_f32_32x32x32_bf16 v[160:175], v[28:31], v[216:223], v240
    v_exp_f32 v120, v120
    v_exp_f32 v121, v121
    v_exp_f32 v122, v122
    v_exp_f32 v123, v123
    v_smfmac_f32_32x32x32_bf16 v[176:191], v[24:27], v[112:119], v240
    v_exp_f32 v124, v124
    v_exp_f32 v125, v125
    v_exp_f32 v126, v126
    v_exp_f32 v127, v127
    s_waitcnt vmcnt(10)
    v_mfma_f32_32x32x16_bf16 v[192:207], v[32:35], v[64:67], 0
    buffer_load_dwordx4 v[16:19], v241, s[20:23], s52 offen offset:0 sc1
    v_exp_f32 v128, v128
    v_exp_f32 v129, v129
    v_exp_f32 v130, v130
    v_exp_f32 v131, v131
    v_mfma_f32_32x32x16_bf16 v[192:207], v[36:39], v[68:71], v[192:207]
    v_exp_f32 v132, v132
    v_exp_f32 v133, v133
    v_exp_f32 v134, v134
    v_exp_f32 v135, v135
    v_smfmac_f32_32x32x32_bf16 v[176:191], v[28:31], v[120:127], v240
    v_exp_f32 v136, v136
    v_exp_f32 v137, v137
    v_exp_f32 v138, v138
    v_exp_f32 v139, v139
    v_smfmac_f32_32x32x32_bf16 v[96:111], v[24:27], v[128:135], v240
    v_exp_f32 v140, v140
    v_exp_f32 v141, v141
    v_exp_f32 v142, v142
    v_exp_f32 v143, v143
    v_mfma_f32_32x32x16_bf16 v[208:223], v[32:35], v[72:75], 0
    buffer_load_dwordx4 v[20:23], v241, s[20:23], s52 offen offset:1024 sc1
    s_mov_b32 s56, s52
    s_add_u32 s52, s52, 4096
    s_and_b32 s52, s52, 0xffff
    v_exp_f32 v192, v192
    v_exp_f32 v193, v193
    v_exp_f32 v194, v194
    v_exp_f32 v195, v195
    v_mfma_f32_32x32x16_bf16 v[208:223], v[36:39], v[76:79], v[208:223]
    v_exp_f32 v196, v196
    v_exp_f32 v197, v197
    v_exp_f32 v198, v198
    v_exp_f32 v199, v199
    v_smfmac_f32_32x32x32_bf16 v[96:111], v[28:31], v[136:143], v240
    v_exp_f32 v200, v200
    v_exp_f32 v201, v201
    v_exp_f32 v202, v202
    v_exp_f32 v203, v203
    s_waitcnt vmcnt(10)
    v_smfmac_f32_32x32x32_bf16 v[144:159], v[40:43], v[192:199], v240
    v_exp_f32 v204, v204
    v_exp_f32 v205, v205
    v_exp_f32 v206, v206
    v_exp_f32 v207, v207
    v_mfma_f32_32x32x16_bf16 v[112:127], v[32:35], v[80:83], 0
    buffer_load_dwordx4 v[24:27], v241, s[20:23], s56 offen offset:2048 sc1
    v_exp_f32 v208, v208
    v_exp_f32 v209, v209
    v_exp_f32 v210, v210
    v_exp_f32 v211, v211
    v_mfma_f32_32x32x16_bf16 v[112:127], v[36:39], v[84:87], v[112:127]
    v_exp_f32 v212, v212
    v_exp_f32 v213, v213
    v_exp_f32 v214, v214
    v_exp_f32 v215, v215
    v_smfmac_f32_32x32x32_bf16 v[144:159], v[44:47], v[200:207], v240
    v_exp_f32 v216, v216
    v_exp_f32 v217, v217
    v_exp_f32 v218, v218
    v_exp_f32 v219, v219
    v_smfmac_f32_32x32x32_bf16 v[160:175], v[40:43], v[208:215], v240
    v_exp_f32 v220, v220
    v_exp_f32 v221, v221
    v_exp_f32 v222, v222
    v_exp_f32 v223, v223
    v_mfma_f32_32x32x16_bf16 v[128:143], v[32:35], v[88:91], 0
    buffer_load_dwordx4 v[28:31], v241, s[20:23], s56 offen offset:3072 sc1
    v_exp_f32 v112, v112
    v_exp_f32 v113, v113
    v_exp_f32 v114, v114
    v_exp_f32 v115, v115
    v_mfma_f32_32x32x16_bf16 v[128:143], v[36:39], v[92:95], v[128:143]
    v_exp_f32 v116, v116
    v_exp_f32 v117, v117
    v_exp_f32 v118, v118
    v_exp_f32 v119, v119
    v_smfmac_f32_32x32x32_bf16 v[160:175], v[44:47], v[216:223], v240
    v_exp_f32 v120, v120
    v_exp_f32 v121, v121
    v_exp_f32 v122, v122
    v_exp_f32 v123, v123
    v_smfmac_f32_32x32x32_bf16 v[176:191], v[40:43], v[112:119], v240
    v_exp_f32 v124, v124
    v_exp_f32 v125, v125
    v_exp_f32 v126, v126
    v_exp_f32 v127, v127
    s_waitcnt vmcnt(10)
    v_mfma_f32_32x32x16_bf16 v[192:207], v[48:51], v[64:67], 0
    buffer_load_dwordx4 v[32:35], v241, s[20:23], s52 offen offset:0 sc1
    v_exp_f32 v128, v128
    v_exp_f32 v129, v129
    v_exp_f32 v130, v130
    v_exp_f32 v131, v131
    v_mfma_f32_32x32x16_bf16 v[192:207], v[52:55], v[68:71], v[192:207]
    v_exp_f32 v132, v132
    v_exp_f32 v133, v133
    v_exp_f32 v134, v134
    v_exp_f32 v135, v135
    v_smfmac_f32_32x32x32_bf16 v[176:191], v[44:47], v[120:127], v240
    v_exp_f32 v136, v136
    v_exp_f32 v137, v137
    v_exp_f32 v138, v138
    v_exp_f32 v139, v139
    v_smfmac_f32_32x32x32_bf16 v[96:111], v[40:43], v[128:135], v240
    v_exp_f32 v140, v140
    v_exp_f32 v141, v141
    v_exp_f32 v142, v142
    v_exp_f32 v143, v143
    v_mfma_f32_32x32x16_bf16 v[208:223], v[48:51], v[72:75], 0
    buffer_load_dwordx4 v[36:39], v241, s[20:23], s52 offen offset:1024 sc1
    s_mov_b32 s56, s52
    s_add_u32 s52, s52, 4096
    s_and_b32 s52, s52, 0xffff
    v_exp_f32 v192, v192
    v_exp_f32 v193, v193
    v_exp_f32 v194, v194
    v_exp_f32 v195, v195
    v_mfma_f32_32x32x16_bf16 v[208:223], v[52:55], v[76:79], v[208:223]
    v_exp_f32 v196, v196
    v_exp_f32 v197, v197
    v_exp_f32 v198, v198
    v_exp_f32 v199, v199
    v_smfmac_f32_32x32x32_bf16 v[96:111], v[44:47], v[136:143], v240
    v_exp_f32 v200, v200
    v_exp_f32 v201, v201
    v_exp_f32 v202, v202
    v_exp_f32 v203, v203
    s_waitcnt vmcnt(10)
    v_smfmac_f32_32x32x32_bf16 v[144:159], v[56:59], v[192:199], v240
    v_exp_f32 v204, v204
    v_exp_f32 v205, v205
    v_exp_f32 v206, v206
    v_exp_f32 v207, v207
    v_mfma_f32_32x32x16_bf16 v[112:127], v[48:51], v[80:83], 0
    buffer_load_dwordx4 v[40:43], v241, s[20:23], s56 offen offset:2048 sc1
    v_exp_f32 v208, v208
    v_exp_f32 v209, v209
    v_exp_f32 v210, v210
    v_exp_f32 v211, v211
    v_mfma_f32_32x32x16_bf16 v[112:127], v[52:55], v[84:87], v[112:127]
    v_exp_f32 v212, v212
    v_exp_f32 v213, v213
    v_exp_f32 v214, v214
    v_exp_f32 v215, v215
    v_smfmac_f32_32x32x32_bf16 v[144:159], v[60:63], v[200:207], v240
    v_exp_f32 v216, v216
    v_exp_f32 v217, v217
    v_exp_f32 v218, v218
    v_exp_f32 v219, v219
    v_smfmac_f32_32x32x32_bf16 v[160:175], v[56:59], v[208:215], v240
    v_exp_f32 v220, v220
    v_exp_f32 v221, v221
    v_exp_f32 v222, v222
    v_exp_f32 v223, v223
    v_mfma_f32_32x32x16_bf16 v[128:143], v[48:51], v[88:91], 0
    buffer_load_dwordx4 v[44:47], v241, s[20:23], s56 offen offset:3072 sc1
    v_exp_f32 v112, v112
    v_exp_f32 v113, v113
    v_exp_f32 v114, v114
    v_exp_f32 v115, v115
    v_mfma_f32_32x32x16_bf16 v[128:143], v[52:55], v[92:95], v[128:143]
    v_exp_f32 v116, v116
    v_exp_f32 v117, v117
    v_exp_f32 v118, v118
    v_exp_f32 v119, v119
    v_smfmac_f32_32x32x32_bf16 v[160:175], v[60:63], v[216:223], v240
    v_exp_f32 v120, v120
    v_exp_f32 v121, v121
    v_exp_f32 v122, v122
    v_exp_f32 v123, v123
    v_smfmac_f32_32x32x32_bf16 v[176:191], v[56:59], v[112:119], v240
    v_exp_f32 v124, v124
    v_exp_f32 v125, v125
    v_exp_f32 v126, v126
    v_exp_f32 v127, v127
    s_waitcnt vmcnt(10)
    v_mfma_f32_32x32x16_bf16 v[192:207], v[0:3], v[64:67], 0
    buffer_load_dwordx4 v[48:51], v241, s[20:23], s52 offen offset:0 sc1
    v_exp_f32 v128, v128
    v_exp_f32 v129, v129
    v_exp_f32 v130, v130
    v_exp_f32 v131, v131
    v_mfma_f32_32x32x16_bf16 v[192:207], v[4:7], v[68:71], v[192:207]
    v_exp_f32 v132, v132
    v_exp_f32 v133, v133
    v_exp_f32 v134, v134
    v_exp_f32 v135, v135
    v_smfmac_f32_32x32x32_bf16 v[176:191], v[60:63], v[120:127], v240
    v_exp_f32 v136, v136
    v_exp_f32 v137, v137
    v_exp_f32 v138, v138
    v_exp_f32 v139, v139
    v_smfmac_f32_32x32x32_bf16 v[96:111], v[56:59], v[128:135], v240
    v_exp_f32 v140, v140
    v_exp_f32 v141, v141
    v_exp_f32 v142, v142
    v_exp_f32 v143, v143
    v_mfma_f32_32x32x16_bf16 v[208:223], v[0:3], v[72:75], 0
    buffer_load_dwordx4 v[52:55], v241, s[20:23], s52 offen offset:1024 sc1
    s_mov_b32 s56, s52
    s_add_u32 s52, s52, 4096
    s_and_b32 s52, s52, 0xffff
    v_exp_f32 v192, v192
    v_exp_f32 v193, v193
    v_exp_f32 v194, v194
    v_exp_f32 v195, v195
    v_mfma_f32_32x32x16_bf16 v[208:223], v[4:7], v[76:79], v[208:223]
    v_exp_f32 v196, v196
    v_exp_f32 v197, v197
    v_exp_f32 v198, v198
    v_exp_f32 v199, v199
    v_smfmac_f32_32x32x32_bf16 v[96:111], v[60:63], v[136:143], v240
    v_exp_f32 v200, v200
    v_exp_f32 v201, v201
    v_exp_f32 v202, v202
    v_exp_f32 v203, v203
    s_waitcnt vmcnt(10)
    v_smfmac_f32_32x32x32_bf16 v[144:159], v[8:11], v[192:199], v240
    v_exp_f32 v204, v204
    v_exp_f32 v205, v205
    v_exp_f32 v206, v206
    v_exp_f32 v207, v207
    v_mfma_f32_32x32x16_bf16 v[112:127], v[0:3], v[80:83], 0
    buffer_load_dwordx4 v[56:59], v241, s[20:23], s56 offen offset:2048 sc1
    v_exp_f32 v208, v208
    v_exp_f32 v209, v209
    v_exp_f32 v210, v210
    v_exp_f32 v211, v211
    v_mfma_f32_32x32x16_bf16 v[112:127], v[4:7], v[84:87], v[112:127]
    v_exp_f32 v212, v212
    v_exp_f32 v213, v213
    v_exp_f32 v214, v214
    v_exp_f32 v215, v215
    v_smfmac_f32_32x32x32_bf16 v[144:159], v[12:15], v[200:207], v240
    v_exp_f32 v216, v216
    v_exp_f32 v217, v217
    v_exp_f32 v218, v218
    v_exp_f32 v219, v219
    v_smfmac_f32_32x32x32_bf16 v[160:175], v[8:11], v[208:215], v240
    v_exp_f32 v220, v220
    v_exp_f32 v221, v221
    v_exp_f32 v222, v222
    v_exp_f32 v223, v223
    v_mfma_f32_32x32x16_bf16 v[128:143], v[0:3], v[88:91], 0
    buffer_load_dwordx4 v[60:63], v241, s[20:23], s56 offen offset:3072 sc1
    v_exp_f32 v112, v112
    v_exp_f32 v113, v113
    v_exp_f32 v114, v114
    v_exp_f32 v115, v115
    v_mfma_f32_32x32x16_bf16 v[128:143], v[4:7], v[92:95], v[128:143]
    v_exp_f32 v116, v116
    v_exp_f32 v117, v117
    v_exp_f32 v118, v118
    v_exp_f32 v119, v119
    v_smfmac_f32_32x32x32_bf16 v[160:175], v[12:15], v[216:223], v240
    v_exp_f32 v120, v120
    v_exp_f32 v121, v121
    v_exp_f32 v122, v122
    v_exp_f32 v123, v123
    v_smfmac_f32_32x32x32_bf16 v[176:191], v[8:11], v[112:119], v240
    v_exp_f32 v124, v124
    v_exp_f32 v125, v125
    v_exp_f32 v126, v126
    v_exp_f32 v127, v127
    s_waitcnt vmcnt(10)
    v_mfma_f32_32x32x16_bf16 v[192:207], v[16:19], v[64:67], 0
    buffer_load_dwordx4 v[0:3], v241, s[20:23], s52 offen offset:0 sc1
    v_exp_f32 v128, v128
    v_exp_f32 v129, v129
    v_exp_f32 v130, v130
    v_exp_f32 v131, v131
    v_mfma_f32_32x32x16_bf16 v[192:207], v[20:23], v[68:71], v[192:207]
    v_exp_f32 v132, v132
    v_exp_f32 v133, v133
    v_exp_f32 v134, v134
    v_exp_f32 v135, v135
    v_smfmac_f32_32x32x32_bf16 v[176:191], v[12:15], v[120:127], v240
    v_exp_f32 v136, v136
    v_exp_f32 v137, v137
    v_exp_f32 v138, v138
    v_exp_f32 v139, v139
    v_smfmac_f32_32x32x32_bf16 v[96:111], v[8:11], v[128:135], v240
    v_exp_f32 v140, v140
    v_exp_f32 v141, v141
    v_exp_f32 v142, v142
    v_exp_f32 v143, v143
    v_mfma_f32_32x32x16_bf16 v[208:223], v[16:19], v[72:75], 0
    buffer_load_dwordx4 v[4:7], v241, s[20:23], s52 offen offset:1024 sc1
    s_mov_b32 s56, s52
    s_add_u32 s52, s52, 4096
    s_and_b32 s52, s52, 0xffff
    v_exp_f32 v192, v192
    v_exp_f32 v193, v193
    v_exp_f32 v194, v194
    v_exp_f32 v195, v195
    v_mfma_f32_32x32x16_bf16 v[208:223], v[20:23], v[76:79], v[208:223]
    v_exp_f32 v196, v196
    v_exp_f32 v197, v197
    v_exp_f32 v198, v198
    v_exp_f32 v199, v199
    v_smfmac_f32_32x32x32_bf16 v[96:111], v[12:15], v[136:143], v240
    v_exp_f32 v200, v200
    v_exp_f32 v201, v201
    v_exp_f32 v202, v202
    v_exp_f32 v203, v203
    s_waitcnt vmcnt(10)
    v_smfmac_f32_32x32x32_bf16 v[144:159], v[24:27], v[192:199], v240
    v_exp_f32 v204, v204
    v_exp_f32 v205, v205
    v_exp_f32 v206, v206
    v_exp_f32 v207, v207
    v_mfma_f32_32x32x16_bf16 v[112:127], v[16:19], v[80:83], 0
    buffer_load_dwordx4 v[8:11], v241, s[20:23], s56 offen offset:2048 sc1
    v_exp_f32 v208, v208
    v_exp_f32 v209, v209
    v_exp_f32 v210, v210
    v_exp_f32 v211, v211
    v_mfma_f32_32x32x16_bf16 v[112:127], v[20:23], v[84:87], v[112:127]
    v_exp_f32 v212, v212
    v_exp_f32 v213, v213
    v_exp_f32 v214, v214
    v_exp_f32 v215, v215
    v_smfmac_f32_32x32x32_bf16 v[144:159], v[28:31], v[200:207], v240
    v_exp_f32 v216, v216
    v_exp_f32 v217, v217
    v_exp_f32 v218, v218
    v_exp_f32 v219, v219
    v_smfmac_f32_32x32x32_bf16 v[160:175], v[24:27], v[208:215], v240
    v_exp_f32 v220, v220
    v_exp_f32 v221, v221
    v_exp_f32 v222, v222
    v_exp_f32 v223, v223
    v_mfma_f32_32x32x16_bf16 v[128:143], v[16:19], v[88:91], 0
    buffer_load_dwordx4 v[12:15], v241, s[20:23], s56 offen offset:3072 sc1
    v_exp_f32 v112, v112
    v_exp_f32 v113, v113
    v_exp_f32 v114, v114
    v_exp_f32 v115, v115
    v_mfma_f32_32x32x16_bf16 v[128:143], v[20:23], v[92:95], v[128:143]
    v_exp_f32 v116, v116
    v_exp_f32 v117, v117
    v_exp_f32 v118, v118
    v_exp_f32 v119, v119
    v_smfmac_f32_32x32x32_bf16 v[160:175], v[28:31], v[216:223], v240
    v_exp_f32 v120, v120
    v_exp_f32 v121, v121
    v_exp_f32 v122, v122
    v_exp_f32 v123, v123
    v_smfmac_f32_32x32x32_bf16 v[176:191], v[24:27], v[112:119], v240
    v_exp_f32 v124, v124
    v_exp_f32 v125, v125
    v_exp_f32 v126, v126
    v_exp_f32 v127, v127
    s_waitcnt vmcnt(10)
    v_mfma_f32_32x32x16_bf16 v[192:207], v[32:35], v[64:67], 0
    buffer_load_dwordx4 v[16:19], v241, s[20:23], s52 offen offset:0 sc1
    v_exp_f32 v128, v128
    v_exp_f32 v129, v129
    v_exp_f32 v130, v130
    v_exp_f32 v131, v131
    v_mfma_f32_32x32x16_bf16 v[192:207], v[36:39], v[68:71], v[192:207]
    v_exp_f32 v132, v132
    v_exp_f32 v133, v133
    v_exp_f32 v134, v134
    v_exp_f32 v135, v135
    v_smfmac_f32_32x32x32_bf16 v[176:191], v[28:31], v[120:127], v240
    v_exp_f32 v136, v136
    v_exp_f32 v137, v137
    v_exp_f32 v138, v138
    v_exp_f32 v139, v139
    v_smfmac_f32_32x32x32_bf16 v[96:111], v[24:27], v[128:135], v240
    v_exp_f32 v140, v140
    v_exp_f32 v141, v141
    v_exp_f32 v142, v142
    v_exp_f32 v143, v143
    v_mfma_f32_32x32x16_bf16 v[208:223], v[32:35], v[72:75], 0
    buffer_load_dwordx4 v[20:23], v241, s[20:23], s52 offen offset:1024 sc1
    s_mov_b32 s56, s52
    s_add_u32 s52, s52, 4096
    s_and_b32 s52, s52, 0xffff
    v_exp_f32 v192, v192
    v_exp_f32 v193, v193
    v_exp_f32 v194, v194
    v_exp_f32 v195, v195
    v_mfma_f32_32x32x16_bf16 v[208:223], v[36:39], v[76:79], v[208:223]
    v_exp_f32 v196, v196
    v_exp_f32 v197, v197
    v_exp_f32 v198, v198
    v_exp_f32 v199, v199
    v_smfmac_f32_32x32x32_bf16 v[96:111], v[28:31], v[136:143], v240
    v_exp_f32 v200, v200
    v_exp_f32 v201, v201
    v_exp_f32 v202, v202
    v_exp_f32 v203, v203
    s_waitcnt vmcnt(10)
    v_smfmac_f32_32x32x32_bf16 v[144:159], v[40:43], v[192:199], v240
    v_exp_f32 v204, v204
    v_exp_f32 v205, v205
    v_exp_f32 v206, v206
    v_exp_f32 v207, v207
    v_mfma_f32_32x32x16_bf16 v[112:127], v[32:35], v[80:83], 0
    buffer_load_dwordx4 v[24:27], v241, s[20:23], s56 offen offset:2048 sc1
    v_exp_f32 v208, v208
    v_exp_f32 v209, v209
    v_exp_f32 v210, v210
    v_exp_f32 v211, v211
    v_mfma_f32_32x32x16_bf16 v[112:127], v[36:39], v[84:87], v[112:127]
    v_exp_f32 v212, v212
    v_exp_f32 v213, v213
    v_exp_f32 v214, v214
    v_exp_f32 v215, v215
    v_smfmac_f32_32x32x32_bf16 v[144:159], v[44:47], v[200:207], v240
    v_exp_f32 v216, v216
    v_exp_f32 v217, v217
    v_exp_f32 v218, v218
    v_exp_f32 v219, v219
    v_smfmac_f32_32x32x32_bf16 v[160:175], v[40:43], v[208:215], v240
    v_exp_f32 v220, v220
    v_exp_f32 v221, v221
    v_exp_f32 v222, v222
    v_exp_f32 v223, v223
    v_mfma_f32_32x32x16_bf16 v[128:143], v[32:35], v[88:91], 0
    buffer_load_dwordx4 v[28:31], v241, s[20:23], s56 offen offset:3072 sc1
    v_exp_f32 v112, v112
    v_exp_f32 v113, v113
    v_exp_f32 v114, v114
    v_exp_f32 v115, v115
    v_mfma_f32_32x32x16_bf16 v[128:143], v[36:39], v[92:95], v[128:143]
    v_exp_f32 v116, v116
    v_exp_f32 v117, v117
    v_exp_f32 v118, v118
    v_exp_f32 v119, v119
    v_smfmac_f32_32x32x32_bf16 v[160:175], v[44:47], v[216:223], v240
    v_exp_f32 v120, v120
    v_exp_f32 v121, v121
    v_exp_f32 v122, v122
    v_exp_f32 v123, v123
    v_smfmac_f32_32x32x32_bf16 v[176:191], v[40:43], v[112:119], v240
    v_exp_f32 v124, v124
    v_exp_f32 v125, v125
    v_exp_f32 v126, v126
    v_exp_f32 v127, v127
    s_waitcnt vmcnt(10)
    v_mfma_f32_32x32x16_bf16 v[192:207], v[48:51], v[64:67], 0
    buffer_load_dwordx4 v[32:35], v241, s[20:23], s52 offen offset:0 sc1
    v_exp_f32 v128, v128
    v_exp_f32 v129, v129
    v_exp_f32 v130, v130
    v_exp_f32 v131, v131
    v_mfma_f32_32x32x16_bf16 v[192:207], v[52:55], v[68:71], v[192:207]
    v_exp_f32 v132, v132
    v_exp_f32 v133, v133
    v_exp_f32 v134, v134
    v_exp_f32 v135, v135
    v_smfmac_f32_32x32x32_bf16 v[176:191], v[44:47], v[120:127], v240
    v_exp_f32 v136, v136
    v_exp_f32 v137, v137
    v_exp_f32 v138, v138
    v_exp_f32 v139, v139
    v_smfmac_f32_32x32x32_bf16 v[96:111], v[40:43], v[128:135], v240
    v_exp_f32 v140, v140
    v_exp_f32 v141, v141
    v_exp_f32 v142, v142
    v_exp_f32 v143, v143
    v_mfma_f32_32x32x16_bf16 v[208:223], v[48:51], v[72:75], 0
    buffer_load_dwordx4 v[36:39], v241, s[20:23], s52 offen offset:1024 sc1
    s_mov_b32 s56, s52
    s_add_u32 s52, s52, 4096
    s_and_b32 s52, s52, 0xffff
    v_exp_f32 v192, v192
    v_exp_f32 v193, v193
    v_exp_f32 v194, v194
    v_exp_f32 v195, v195
    v_mfma_f32_32x32x16_bf16 v[208:223], v[52:55], v[76:79], v[208:223]
    v_exp_f32 v196, v196
    v_exp_f32 v197, v197
    v_exp_f32 v198, v198
    v_exp_f32 v199, v199
    v_smfmac_f32_32x32x32_bf16 v[96:111], v[44:47], v[136:143], v240
    v_exp_f32 v200, v200
    v_exp_f32 v201, v201
    v_exp_f32 v202, v202
    v_exp_f32 v203, v203
    s_waitcnt vmcnt(10)
    v_smfmac_f32_32x32x32_bf16 v[144:159], v[56:59], v[192:199], v240
    v_exp_f32 v204, v204
    v_exp_f32 v205, v205
    v_exp_f32 v206, v206
    v_exp_f32 v207, v207
    v_mfma_f32_32x32x16_bf16 v[112:127], v[48:51], v[80:83], 0
    buffer_load_dwordx4 v[40:43], v241, s[20:23], s56 offen offset:2048 sc1
    v_exp_f32 v208, v208
    v_exp_f32 v209, v209
    v_exp_f32 v210, v210
    v_exp_f32 v211, v211
    v_mfma_f32_32x32x16_bf16 v[112:127], v[52:55], v[84:87], v[112:127]
    v_exp_f32 v212, v212
    v_exp_f32 v213, v213
    v_exp_f32 v214, v214
    v_exp_f32 v215, v215
    v_smfmac_f32_32x32x32_bf16 v[144:159], v[60:63], v[200:207], v240
    v_exp_f32 v216, v216
    v_exp_f32 v217, v217
    v_exp_f32 v218, v218
    v_exp_f32 v219, v219
    v_smfmac_f32_32x32x32_bf16 v[160:175], v[56:59], v[208:215], v240
    v_exp_f32 v220, v220
    v_exp_f32 v221, v221
    v_exp_f32 v222, v222
    v_exp_f32 v223, v223
    v_mfma_f32_32x32x16_bf16 v[128:143], v[48:51], v[88:91], 0
    buffer_load_dwordx4 v[44:47], v241, s[20:23], s56 offen offset:3072 sc1
    v_exp_f32 v112, v112
    v_exp_f32 v113, v113
    v_exp_f32 v114, v114
    v_exp_f32 v115, v115
    v_mfma_f32_32x32x16_bf16 v[128:143], v[52:55], v[92:95], v[128:143]
    v_exp_f32 v116, v116
    v_exp_f32 v117, v117
    v_exp_f32 v118, v118
    v_exp_f32 v119, v119
    v_smfmac_f32_32x32x32_bf16 v[160:175], v[60:63], v[216:223], v240
    v_exp_f32 v120, v120
    v_exp_f32 v121, v121
    v_exp_f32 v122, v122
    v_exp_f32 v123, v123
    v_smfmac_f32_32x32x32_bf16 v[176:191], v[56:59], v[112:119], v240
    v_exp_f32 v124, v124
    v_exp_f32 v125, v125
    v_exp_f32 v126, v126
    v_exp_f32 v127, v127
    s_waitcnt vmcnt(10)
    v_mfma_f32_32x32x16_bf16 v[192:207], v[0:3], v[64:67], 0
    buffer_load_dwordx4 v[48:51], v241, s[20:23], s52 offen offset:0 sc1
    v_exp_f32 v128, v128
    v_exp_f32 v129, v129
    v_exp_f32 v130, v130
    v_exp_f32 v131, v131
    v_mfma_f32_32x32x16_bf16 v[192:207], v[4:7], v[68:71], v[192:207]
    v_exp_f32 v132, v132
    v_exp_f32 v133, v133
    v_exp_f32 v134, v134
    v_exp_f32 v135, v135
    v_smfmac_f32_32x32x32_bf16 v[176:191], v[60:63], v[120:127], v240
    v_exp_f32 v136, v136
    v_exp_f32 v137, v137
    v_exp_f32 v138, v138
    v_exp_f32 v139, v139
    v_smfmac_f32_32x32x32_bf16 v[96:111], v[56:59], v[128:135], v240
    v_exp_f32 v140, v140
    v_exp_f32 v141, v141
    v_exp_f32 v142, v142
    v_exp_f32 v143, v143
    v_mfma_f32_32x32x16_bf16 v[208:223], v[0:3], v[72:75], 0
    buffer_load_dwordx4 v[52:55], v241, s[20:23], s52 offen offset:1024 sc1
    s_mov_b32 s56, s52
    s_add_u32 s52, s52, 4096
    s_and_b32 s52, s52, 0xffff
    v_exp_f32 v192, v192
    v_exp_f32 v193, v193
    v_exp_f32 v194, v194
    v_exp_f32 v195, v195
    v_mfma_f32_32x32x16_bf16 v[208:223], v[4:7], v[76:79], v[208:223]
    v_exp_f32 v196, v196
    v_exp_f32 v197, v197
    v_exp_f32 v198, v198
    v_exp_f32 v199, v199
    v_smfmac_f32_32x32x32_bf16 v[96:111], v[60:63], v[136:143], v240
    v_exp_f32 v200, v200
    v_exp_f32 v201, v201
    v_exp_f32 v202, v202
    v_exp_f32 v203, v203
    s_waitcnt vmcnt(10)
    v_smfmac_f32_32x32x32_bf16 v[144:159], v[8:11], v[192:199], v240
    v_exp_f32 v204, v204
    v_exp_f32 v205, v205
    v_exp_f32 v206, v206
    v_exp_f32 v207, v207
    v_mfma_f32_32x32x16_bf16 v[112:127], v[0:3], v[80:83], 0
    buffer_load_dwordx4 v[56:59], v241, s[20:23], s56 offen offset:2048 sc1
    v_exp_f32 v208, v208
    v_exp_f32 v209, v209
    v_exp_f32 v210, v210
    v_exp_f32 v211, v211
    v_mfma_f32_32x32x16_bf16 v[112:127], v[4:7], v[84:87], v[112:127]
    v_exp_f32 v212, v212
    v_exp_f32 v213, v213
    v_exp_f32 v214, v214
    v_exp_f32 v215, v215
    v_smfmac_f32_32x32x32_bf16 v[144:159], v[12:15], v[200:207], v240
    v_exp_f32 v216, v216
    v_exp_f32 v217, v217
    v_exp_f32 v218, v218
    v_exp_f32 v219, v219
    v_smfmac_f32_32x32x32_bf16 v[160:175], v[8:11], v[208:215], v240
    v_exp_f32 v220, v220
    v_exp_f32 v221, v221
    v_exp_f32 v222, v222
    v_exp_f32 v223, v223
    v_mfma_f32_32x32x16_bf16 v[128:143], v[0:3], v[88:91], 0
    buffer_load_dwordx4 v[60:63], v241, s[20:23], s56 offen offset:3072 sc1
    v_exp_f32 v112, v112
    v_exp_f32 v113, v113
    v_exp_f32 v114, v114
    v_exp_f32 v115, v115
    v_mfma_f32_32x32x16_bf16 v[128:143], v[4:7], v[92:95], v[128:143]
    v_exp_f32 v116, v116
    v_exp_f32 v117, v117
    v_exp_f32 v118, v118
    v_exp_f32 v119, v119
    v_smfmac_f32_32x32x32_bf16 v[160:175], v[12:15], v[216:223], v240
    v_exp_f32 v120, v120
    v_exp_f32 v121, v121
    v_exp_f32 v122, v122
    v_exp_f32 v123, v123
    v_smfmac_f32_32x32x32_bf16 v[176:191], v[8:11], v[112:119], v240
    v_exp_f32 v124, v124
    v_exp_f32 v125, v125
    v_exp_f32 v126, v126
    v_exp_f32 v127, v127
    s_waitcnt vmcnt(10)
    v_mfma_f32_32x32x16_bf16 v[192:207], v[16:19], v[64:67], 0
    v_exp_f32 v128, v128
    v_exp_f32 v129, v129
    v_exp_f32 v130, v130
    v_exp_f32 v131, v131
    v_mfma_f32_32x32x16_bf16 v[192:207], v[20:23], v[68:71], v[192:207]
    v_exp_f32 v132, v132
    v_exp_f32 v133, v133
    v_exp_f32 v134, v134
    v_exp_f32 v135, v135
    v_smfmac_f32_32x32x32_bf16 v[176:191], v[12:15], v[120:127], v240
    v_exp_f32 v136, v136
    v_exp_f32 v137, v137
    v_exp_f32 v138, v138
    v_exp_f32 v139, v139
    v_smfmac_f32_32x32x32_bf16 v[96:111], v[8:11], v[128:135], v240
    v_exp_f32 v140, v140
    v_exp_f32 v141, v141
    v_exp_f32 v142, v142
    v_exp_f32 v143, v143
    v_mfma_f32_32x32x16_bf16 v[208:223], v[16:19], v[72:75], 0
    v_exp_f32 v192, v192
    v_exp_f32 v193, v193
    v_exp_f32 v194, v194
    v_exp_f32 v195, v195
    v_mfma_f32_32x32x16_bf16 v[208:223], v[20:23], v[76:79], v[208:223]
    v_exp_f32 v196, v196
    v_exp_f32 v197, v197
    v_exp_f32 v198, v198
    v_exp_f32 v199, v199
    v_smfmac_f32_32x32x32_bf16 v[96:111], v[12:15], v[136:143], v240
    v_exp_f32 v200, v200
    v_exp_f32 v201, v201
    v_exp_f32 v202, v202
    v_exp_f32 v203, v203
    s_waitcnt vmcnt(8)
    v_smfmac_f32_32x32x32_bf16 v[144:159], v[24:27], v[192:199], v240
    v_exp_f32 v204, v204
    v_exp_f32 v205, v205
    v_exp_f32 v206, v206
    v_exp_f32 v207, v207
    v_mfma_f32_32x32x16_bf16 v[112:127], v[16:19], v[80:83], 0
    v_exp_f32 v208, v208
    v_exp_f32 v209, v209
    v_exp_f32 v210, v210
    v_exp_f32 v211, v211
    v_mfma_f32_32x32x16_bf16 v[112:127], v[20:23], v[84:87], v[112:127]
    v_exp_f32 v212, v212
    v_exp_f32 v213, v213
    v_exp_f32 v214, v214
    v_exp_f32 v215, v215
    v_smfmac_f32_32x32x32_bf16 v[144:159], v[28:31], v[200:207], v240
    v_exp_f32 v216, v216
    v_exp_f32 v217, v217
    v_exp_f32 v218, v218
    v_exp_f32 v219, v219
    v_smfmac_f32_32x32x32_bf16 v[160:175], v[24:27], v[208:215], v240
    v_exp_f32 v220, v220
    v_exp_f32 v221, v221
    v_exp_f32 v222, v222
    v_exp_f32 v223, v223
    v_mfma_f32_32x32x16_bf16 v[128:143], v[16:19], v[88:91], 0
    v_exp_f32 v112, v112
    v_exp_f32 v113, v113
    v_exp_f32 v114, v114
    v_exp_f32 v115, v115
    v_mfma_f32_32x32x16_bf16 v[128:143], v[20:23], v[92:95], v[128:143]
    v_exp_f32 v116, v116
    v_exp_f32 v117, v117
    v_exp_f32 v118, v118
    v_exp_f32 v119, v119
    v_smfmac_f32_32x32x32_bf16 v[160:175], v[28:31], v[216:223], v240
    v_exp_f32 v120, v120
    v_exp_f32 v121, v121
    v_exp_f32 v122, v122
    v_exp_f32 v123, v123
    v_smfmac_f32_32x32x32_bf16 v[176:191], v[24:27], v[112:119], v240
    v_exp_f32 v124, v124
    v_exp_f32 v125, v125
    v_exp_f32 v126, v126
    v_exp_f32 v127, v127
    s_waitcnt vmcnt(6)
    v_mfma_f32_32x32x16_bf16 v[192:207], v[32:35], v[64:67], 0
    v_exp_f32 v128, v128
    v_exp_f32 v129, v129
    v_exp_f32 v130, v130
    v_exp_f32 v131, v131
    v_mfma_f32_32x32x16_bf16 v[192:207], v[36:39], v[68:71], v[192:207]
    v_exp_f32 v132, v132
    v_exp_f32 v133, v133
    v_exp_f32 v134, v134
    v_exp_f32 v135, v135
    v_smfmac_f32_32x32x32_bf16 v[176:191], v[28:31], v[120:127], v240
    v_exp_f32 v136, v136
    v_exp_f32 v137, v137
    v_exp_f32 v138, v138
    v_exp_f32 v139, v139
    v_smfmac_f32_32x32x32_bf16 v[96:111], v[24:27], v[128:135], v240
    v_exp_f32 v140, v140
    v_exp_f32 v141, v141
    v_exp_f32 v142, v142
    v_exp_f32 v143, v143
    v_mfma_f32_32x32x16_bf16 v[208:223], v[32:35], v[72:75], 0
    v_exp_f32 v192, v192
    v_exp_f32 v193, v193
    v_exp_f32 v194, v194
    v_exp_f32 v195, v195
    v_mfma_f32_32x32x16_bf16 v[208:223], v[36:39], v[76:79], v[208:223]
    v_exp_f32 v196, v196
    v_exp_f32 v197, v197
    v_exp_f32 v198, v198
    v_exp_f32 v199, v199
    v_smfmac_f32_32x32x32_bf16 v[96:111], v[28:31], v[136:143], v240
    v_exp_f32 v200, v200
    v_exp_f32 v201, v201
    v_exp_f32 v202, v202
    v_exp_f32 v203, v203
    s_waitcnt vmcnt(4)
    v_smfmac_f32_32x32x32_bf16 v[144:159], v[40:43], v[192:199], v240
    v_exp_f32 v204, v204
    v_exp_f32 v205, v205
    v_exp_f32 v206, v206
    v_exp_f32 v207, v207
    v_mfma_f32_32x32x16_bf16 v[112:127], v[32:35], v[80:83], 0
    v_exp_f32 v208, v208
    v_exp_f32 v209, v209
    v_exp_f32 v210, v210
    v_exp_f32 v211, v211
    v_mfma_f32_32x32x16_bf16 v[112:127], v[36:39], v[84:87], v[112:127]
    v_exp_f32 v212, v212
    v_exp_f32 v213, v213
    v_exp_f32 v214, v214
    v_exp_f32 v215, v215
    v_smfmac_f32_32x32x32_bf16 v[144:159], v[44:47], v[200:207], v240
    v_exp_f32 v216, v216
    v_exp_f32 v217, v217
    v_exp_f32 v218, v218
    v_exp_f32 v219, v219
    v_smfmac_f32_32x32x32_bf16 v[160:175], v[40:43], v[208:215], v240
    v_exp_f32 v220, v220
    v_exp_f32 v221, v221
    v_exp_f32 v222, v222
    v_exp_f32 v223, v223
    v_mfma_f32_32x32x16_bf16 v[128:143], v[32:35], v[88:91], 0
    v_exp_f32 v112, v112
    v_exp_f32 v113, v113
    v_exp_f32 v114, v114
    v_exp_f32 v115, v115
    v_mfma_f32_32x32x16_bf16 v[128:143], v[36:39], v[92:95], v[128:143]
    v_exp_f32 v116, v116
    v_exp_f32 v117, v117
    v_exp_f32 v118, v118
    v_exp_f32 v119, v119
    v_smfmac_f32_32x32x32_bf16 v[160:175], v[44:47], v[216:223], v240
    v_exp_f32 v120, v120
    v_exp_f32 v121, v121
    v_exp_f32 v122, v122
    v_exp_f32 v123, v123
    v_smfmac_f32_32x32x32_bf16 v[176:191], v[40:43], v[112:119], v240
    v_exp_f32 v124, v124
    v_exp_f32 v125, v125
    v_exp_f32 v126, v126
    v_exp_f32 v127, v127
    s_waitcnt vmcnt(2)
    v_mfma_f32_32x32x16_bf16 v[192:207], v[48:51], v[64:67], 0
    v_exp_f32 v128, v128
    v_exp_f32 v129, v129
    v_exp_f32 v130, v130
    v_exp_f32 v131, v131
    v_mfma_f32_32x32x16_bf16 v[192:207], v[52:55], v[68:71], v[192:207]
    v_exp_f32 v132, v132
    v_exp_f32 v133, v133
    v_exp_f32 v134, v134
    v_exp_f32 v135, v135
    v_smfmac_f32_32x32x32_bf16 v[176:191], v[44:47], v[120:127], v240
    v_exp_f32 v136, v136
    v_exp_f32 v137, v137
    v_exp_f32 v138, v138
    v_exp_f32 v139, v139
    v_smfmac_f32_32x32x32_bf16 v[96:111], v[40:43], v[128:135], v240
    v_exp_f32 v140, v140
    v_exp_f32 v141, v141
    v_exp_f32 v142, v142
    v_exp_f32 v143, v143
    v_mfma_f32_32x32x16_bf16 v[208:223], v[48:51], v[72:75], 0
    v_exp_f32 v192, v192
    v_exp_f32 v193, v193
    v_exp_f32 v194, v194
    v_exp_f32 v195, v195
    v_mfma_f32_32x32x16_bf16 v[208:223], v[52:55], v[76:79], v[208:223]
    v_exp_f32 v196, v196
    v_exp_f32 v197, v197
    v_exp_f32 v198, v198
    v_exp_f32 v199, v199
    v_smfmac_f32_32x32x32_bf16 v[96:111], v[44:47], v[136:143], v240
    v_exp_f32 v200, v200
    v_exp_f32 v201, v201
    v_exp_f32 v202, v202
    v_exp_f32 v203, v203
    s_waitcnt vmcnt(0)
    v_smfmac_f32_32x32x32_bf16 v[144:159], v[56:59], v[192:199], v240
    v_exp_f32 v204, v204
    v_exp_f32 v205, v205
    v_exp_f32 v206, v206
    v_exp_f32 v207, v207
    v_mfma_f32_32x32x16_bf16 v[112:127], v[48:51], v[80:83], 0
    v_exp_f32 v208, v208
    v_exp_f32 v209, v209
    v_exp_f32 v210, v210
    v_exp_f32 v211, v211
    v_mfma_f32_32x32x16_bf16 v[112:127], v[52:55], v[84:87], v[112:127]
    v_exp_f32 v212, v212
    v_exp_f32 v213, v213
    v_exp_f32 v214, v214
    v_exp_f32 v215, v215
    v_smfmac_f32_32x32x32_bf16 v[144:159], v[60:63], v[200:207], v240
    v_exp_f32 v216, v216
    v_exp_f32 v217, v217
    v_exp_f32 v218, v218
    v_exp_f32 v219, v219
    v_smfmac_f32_32x32x32_bf16 v[160:175], v[56:59], v[208:215], v240
    v_exp_f32 v220, v220
    v_exp_f32 v221, v221
    v_exp_f32 v222, v222
    v_exp_f32 v223, v223
    v_mfma_f32_32x32x16_bf16 v[128:143], v[48:51], v[88:91], 0
    v_exp_f32 v112, v112
    v_exp_f32 v113, v113
    v_exp_f32 v114, v114
    v_exp_f32 v115, v115
    s_add_u32 s53, s43, 1
    s_and_b32 s53, s53, 3
    s_mul_i32 s53, s53, 12288
    s_add_u32 s53, s53, 98304
    v_add_u32 v254, s53, v244
    ds_write_b128 v254, v[144:147] offset:0
    ds_write_b128 v254, v[148:151] offset:1024
    ds_write_b128 v254, v[152:155] offset:2048
    ds_write_b128 v254, v[156:159] offset:3072
    v_mfma_f32_32x32x16_bf16 v[128:143], v[52:55], v[92:95], v[128:143]
    v_exp_f32 v116, v116
    v_exp_f32 v117, v117
    v_exp_f32 v118, v118
    v_exp_f32 v119, v119
    v_smfmac_f32_32x32x32_bf16 v[160:175], v[60:63], v[216:223], v240
    v_exp_f32 v120, v120
    v_exp_f32 v121, v121
    v_exp_f32 v122, v122
    v_exp_f32 v123, v123
    v_smfmac_f32_32x32x32_bf16 v[176:191], v[56:59], v[112:119], v240
    v_exp_f32 v124, v124
    v_exp_f32 v125, v125
    v_exp_f32 v126, v126
    v_exp_f32 v127, v127
    v_exp_f32 v128, v128
    v_exp_f32 v129, v129
    v_exp_f32 v130, v130
    v_exp_f32 v131, v131
    s_add_u32 s53, s43, 2
    s_and_b32 s53, s53, 3
    s_mul_i32 s53, s53, 12288
    s_add_u32 s53, s53, 102400
    v_add_u32 v254, s53, v244
    ds_write_b128 v254, v[160:163] offset:0
    ds_write_b128 v254, v[164:167] offset:1024
    ds_write_b128 v254, v[168:171] offset:2048
    ds_write_b128 v254, v[172:175] offset:3072
    v_exp_f32 v132, v132
    v_exp_f32 v133, v133
    v_exp_f32 v134, v134
    v_exp_f32 v135, v135
    v_smfmac_f32_32x32x32_bf16 v[176:191], v[60:63], v[120:127], v240
    v_exp_f32 v136, v136
    v_exp_f32 v137, v137
    v_exp_f32 v138, v138
    v_exp_f32 v139, v139
    v_smfmac_f32_32x32x32_bf16 v[96:111], v[56:59], v[128:135], v240
    v_exp_f32 v140, v140
    v_exp_f32 v141, v141
    v_exp_f32 v142, v142
    v_exp_f32 v143, v143
    s_add_u32 s53, s43, 3
    s_and_b32 s53, s53, 3
    s_mul_i32 s53, s53, 12288
    s_add_u32 s53, s53, 106496
    v_add_u32 v254, s53, v244
    ds_write_b128 v254, v[176:179] offset:0
    ds_write_b128 v254, v[180:183] offset:1024
    ds_write_b128 v254, v[184:187] offset:2048
    ds_write_b128 v254, v[188:191] offset:3072
    v_smfmac_f32_32x32x32_bf16 v[96:111], v[60:63], v[136:143], v240
    s_mul_i32 s53, s43, 12288
    s_add_u32 s53, s53, 98304
    v_add_u32 v254, s53, v244
    s_lshl_b32 s55, s40, 2
    s_add_u32 s55, s55, s43
    s_lshl_b32 s55, s55, 5
    s_lshl_b32 s53, s41, 1
    s_add_u32 s55, s55, s53
    s_lshl_b32 s55, s55, 10
    s_add_u32 s55, s55, 8388608
    s_lshl_b32 s54, s40, 13
    s_add_u32 s54, s54, 10486784
    s_mul_i32 s53, s43, 1792
    s_add_u32 s54, s54, s53
    s_lshr_b32 s53, s41, 3
    s_mul_i32 s53, s53, 896
    s_add_u32 s54, s54, s53
    s_lshl_b32 s53, s101, 2
    s_add_u32 s54, s54, s53
    v_lshlrev_b32 v242, 7, v255
    v_mov_b32 v243, 1
    s_waitcnt lgkmcnt(0)
    s_barrier
    ds_read_b128 v[204:207], v254 offset:3072
    ds_read_b128 v[220:223], v254 offset:7168
    ds_read_b128 v[124:127], v254 offset:11264
    ds_read_b128 v[192:195], v254 offset:0
    ds_read_b128 v[208:211], v254 offset:4096
    ds_read_b128 v[112:115], v254 offset:8192
    ds_read_b128 v[196:199], v254 offset:1024
    ds_read_b128 v[212:215], v254 offset:5120
    ds_read_b128 v[116:119], v254 offset:9216
    ds_read_b128 v[200:203], v254 offset:2048
    ds_read_b128 v[216:219], v254 offset:6144
    ds_read_b128 v[120:123], v254 offset:10240
    s_waitcnt lgkmcnt(9)
    v_add_f32 v108, v108, v204
    v_add_f32 v109, v109, v205
    v_add_f32 v110, v110, v206
    v_add_f32 v111, v111, v207
    v_add_f32 v108, v108, v220
    v_add_f32 v109, v109, v221
    v_add_f32 v110, v110, v222
    v_add_f32 v111, v111, v223
    v_add_f32 v108, v108, v124
    v_add_f32 v109, v109, v125
    v_add_f32 v110, v110, v126
    v_add_f32 v111, v111, v127
    v_mov_b32 v250, v108
    v_mov_b32 v251, v108
    s_waitcnt lgkmcnt(6)
    v_add_f32 v96, v96, v192
    v_add_f32 v97, v97, v193
    v_permlane32_swap_b32 v250, v251
    v_add_f32 v98, v98, v194
    v_add_f32 v99, v99, v195
    v_cmp_le_f32 vcc, 0x21800000, v251
    v_mov_b32 v250, 0x5d800000
    v_cmp_ge_f32 s[44:45], v250, v251
    v_add_f32 v96, v96, v208
    v_add_f32 v97, v97, v209
    v_add_f32 v98, v98, v210
    v_add_f32 v99, v99, v211
    v_add_f32 v96, v96, v112
    v_add_f32 v97, v97, v113
    v_add_f32 v98, v98, v114
    v_add_f32 v99, v99, v115
    s_waitcnt lgkmcnt(3)
    v_add_f32 v100, v100, v196
    v_add_f32 v101, v101, v197
    v_add_f32 v102, v102, v198
    v_add_f32 v103, v103, v199
    v_add_f32 v100, v100, v212
    v_add_f32 v101, v101, v213
    v_add_f32 v102, v102, v214
    v_add_f32 v103, v103, v215
    v_add_f32 v100, v100, v116
    v_add_f32 v101, v101, v117
    v_add_f32 v102, v102, v118
    v_add_f32 v103, v103, v119
    s_waitcnt lgkmcnt(0)
    v_add_f32 v104, v104, v200
    v_add_f32 v105, v105, v201
    v_add_f32 v106, v106, v202
    v_add_f32 v107, v107, v203
    v_add_f32 v104, v104, v216
    v_add_f32 v105, v105, v217
    v_add_f32 v106, v106, v218
    v_add_f32 v107, v107, v219
    v_add_f32 v104, v104, v120
    v_add_f32 v105, v105, v121
    v_add_f32 v106, v106, v122
    v_add_f32 v107, v107, v123
    s_and_b64 s[44:45], s[44:45], vcc
    s_cmp_eq_u64 s[44:45], -1
    s_cbranch_scc0 L_slow
L_norm:
    v_rcp_f32 v251, v251
    v_cmp_gt_u32 vcc, 32, v255
    v_mul_f32 v96, v251, v96
    v_mul_f32 v97, v251, v97
    v_mul_f32 v98, v251, v98
    v_mul_f32 v99, v251, v99
    v_mul_f32 v100, v251, v100
    v_mul_f32 v101, v251, v101
    v_mul_f32 v102, v251, v102
    v_mul_f32 v103, v251, v103
    v_cndmask_b32 v250, 0, v251, vcc
    v_cvt_pk_bf16_f32 v96, v96, v97
    v_cvt_pk_bf16_f32 v97, v98, v99
    v_cvt_pk_bf16_f32 v98, v100, v101
    v_cvt_pk_bf16_f32 v99, v102, v103
    buffer_store_dwordx4 v[96:99], v244, s[20:23], s55 offen sc1
    v_mul_f32 v104, v251, v104
    v_mul_f32 v105, v251, v105
    v_mul_f32 v106, v251, v106
    v_mul_f32 v107, v251, v107
    v_mul_f32 v108, v250, v108
    v_mul_f32 v109, v250, v109
    v_mul_f32 v110, v250, v110
    v_mul_f32 v111, v250, v111
    v_cvt_pk_bf16_f32 v100, v104, v105
    v_cvt_pk_bf16_f32 v101, v106, v107
    v_cvt_pk_bf16_f32 v102, v108, v109
    v_cvt_pk_bf16_f32 v103, v110, v111
    buffer_store_dwordx4 v[100:103], v244, s[20:23], s55 offen offset:1024 sc1
    s_waitcnt vmcnt(0)
    s_mov_b64 exec, 0x7f
    buffer_store_dword v243, v242, s[20:23], s54 offen sc1
    s_mov_b64 exec, -1
    s_endpgm
L_slow:
    v_mov_b32 v254, 0xff800000
    s_mov_b32 s52, 0
L_slow1:
    buffer_load_dwordx4 v[0:3], v244, s[20:23], s52 offen offset:0 sc1
    buffer_load_dwordx4 v[4:7], v244, s[20:23], s52 offen offset:1024 sc1
    s_waitcnt vmcnt(0)
    v_mfma_f32_32x32x16_bf16 v[128:143], v[0:3], v[88:91], 0
    v_mfma_f32_32x32x16_bf16 v[128:143], v[4:7], v[92:95], v[128:143]
    s_nop 7
    s_nop 3
    v_max3_f32 v254, v254, v128, v129
    v_max3_f32 v254, v254, v130, v131
    v_max3_f32 v254, v254, v132, v133
    v_max3_f32 v254, v254, v134, v135
    v_max3_f32 v254, v254, v136, v137
    v_max3_f32 v254, v254, v138, v139
    v_max3_f32 v254, v254, v140, v141
    v_max3_f32 v254, v254, v142, v143
    s_add_u32 s52, s52, 4096
    s_cmp_lt_u32 s52, 262144
    s_cbranch_scc1 L_slow1
    v_mov_b32 v250, v254
    s_nop 1
    v_permlane32_swap_b32 v254, v250
    s_nop 1
    v_max_f32 v254, v254, v250
    v_mov_b32 v96, 0
    v_mov_b32 v97, 0
    v_mov_b32 v98, 0
    v_mov_b32 v99, 0
    v_mov_b32 v100, 0
    v_mov_b32 v101, 0
    v_mov_b32 v102, 0
    v_mov_b32 v103, 0
    v_mov_b32 v104, 0
    v_mov_b32 v105, 0
    v_mov_b32 v106, 0
    v_mov_b32 v107, 0
    v_mov_b32 v108, 0
    v_mov_b32 v109, 0
    v_mov_b32 v110, 0
    v_mov_b32 v111, 0
    s_mov_b32 s52, 0
L_slow2:
    buffer_load_dwordx4 v[0:3], v244, s[20:23], s52 offen offset:0 sc1
    buffer_load_dwordx4 v[4:7], v244, s[20:23], s52 offen offset:1024 sc1
    buffer_load_dwordx4 v[8:11], v244, s[20:23], s52 offen offset:2048 sc1
    buffer_load_dwordx4 v[12:15], v244, s[20:23], s52 offen offset:3072 sc1
    s_waitcnt vmcnt(0)
    v_mfma_f32_32x32x16_bf16 v[128:143], v[0:3], v[88:91], 0
    v_mfma_f32_32x32x16_bf16 v[128:143], v[4:7], v[92:95], v[128:143]
    s_nop 7
    s_nop 3
    v_sub_f32 v128, v128, v254
    v_sub_f32 v129, v129, v254
    v_sub_f32 v130, v130, v254
    v_sub_f32 v131, v131, v254
    v_sub_f32 v132, v132, v254
    v_sub_f32 v133, v133, v254
    v_sub_f32 v134, v134, v254
    v_sub_f32 v135, v135, v254
    v_sub_f32 v136, v136, v254
    v_sub_f32 v137, v137, v254
    v_sub_f32 v138, v138, v254
    v_sub_f32 v139, v139, v254
    v_sub_f32 v140, v140, v254
    v_sub_f32 v141, v141, v254
    v_sub_f32 v142, v142, v254
    v_sub_f32 v143, v143, v254
    v_exp_f32 v128, v128
    v_exp_f32 v129, v129
    v_exp_f32 v130, v130
    v_exp_f32 v131, v131
    v_exp_f32 v132, v132
    v_exp_f32 v133, v133
    v_exp_f32 v134, v134
    v_exp_f32 v135, v135
    v_exp_f32 v136, v136
    v_exp_f32 v137, v137
    v_exp_f32 v138, v138
    v_exp_f32 v139, v139
    v_exp_f32 v140, v140
    v_exp_f32 v141, v141
    v_exp_f32 v142, v142
    v_exp_f32 v143, v143
    s_nop 1
    v_smfmac_f32_32x32x32_bf16 v[96:111], v[8:11], v[128:135], v240
    v_smfmac_f32_32x32x32_bf16 v[96:111], v[12:15], v[136:143], v240
    s_add_u32 s52, s52, 4096
    s_cmp_lt_u32 s52, 262144
    s_cbranch_scc1 L_slow2
    s_nop 7
    s_nop 3
    v_mov_b32 v250, v108
    v_mov_b32 v251, v108
    s_nop 1
    v_permlane32_swap_b32 v250, v251
    s_nop 1
    s_branch L_norm
L_AS:
    v_sub_f32 v160, 0, v252
    v_mov_b32 v161, v160
    v_mov_b32 v162, v160
    v_mov_b32 v163, v160
    v_mov_b32 v164, v160
    v_mov_b32 v165, v160
    v_mov_b32 v166, v160
    v_mov_b32 v167, v160
    v_mov_b32 v168, v160
    v_mov_b32 v169, v160
    v_mov_b32 v170, v160
    v_mov_b32 v171, v160
    v_mov_b32 v172, v160
    v_mov_b32 v173, v160
    v_mov_b32 v174, v160
    v_mov_b32 v175, v160
    s_nop 1
    v_mfma_f32_32x32x16_bf16 v[176:191], v[224:227], v[0:3], v[160:175]
    v_cvt_pk_bf16_f32 v247, v247, v247
    v_and_b32 v247, s48, v247
    v_add_f32 v247, 0x3727c5ac, v247
    v_cvt_pk_bf16_f32 v247, v247, v247
    v_and_b32 v247, s48, v247
    v_mfma_f32_32x32x16_bf16 v[176:191], v[228:231], v[4:7], v[176:191]
    v_sqrt_f32 v247, v247
    s_nop 0
    v_cvt_pk_bf16_f32 v247, v247, v247
    v_and_b32 v247, s48, v247
    v_rcp_f32 v253, v247
    v_mfma_f32_32x32x16_bf16 v[192:207], v[224:227], v[8:11], v[160:175]
    v_mul_f32 v247, v247, v247
    v_mul_f32 v249, 0x3e8b97f6, v253
    v_mul_f32 v245, 0xc0135761, v253
    v_mul_f32 v246, v253, v253
    v_mul_f32 v246, v246, v245
    v_mfma_f32_32x32x16_bf16 v[192:207], v[228:231], v[12:15], v[192:207]
    v_mul_f32 v246, 0x3d372713, v246
    v_mfma_f32_32x32x16_bf16 v[208:223], v[224:227], v[16:19], v[160:175]
    v_cvt_pk_bf16_f32 v0, v176, v177
    v_cvt_pk_bf16_f32 v1, v178, v179
    v_cvt_pk_bf16_f32 v2, v180, v181
    v_cvt_pk_bf16_f32 v3, v182, v183
    v_mfma_f32_32x32x16_bf16 v[208:223], v[228:231], v[20:23], v[208:223]
    v_cvt_pk_bf16_f32 v4, v184, v185
    v_cvt_pk_bf16_f32 v5, v186, v187
    v_cvt_pk_bf16_f32 v6, v188, v189
    v_cvt_pk_bf16_f32 v7, v190, v191
    v_mfma_f32_32x32x16_bf16 v[176:191], v[224:227], v[24:27], v[160:175]
    v_cvt_pk_bf16_f32 v8, v192, v193
    v_cvt_pk_bf16_f32 v9, v194, v195
    v_cvt_pk_bf16_f32 v10, v196, v197
    v_cvt_pk_bf16_f32 v11, v198, v199
    v_mfma_f32_32x32x16_bf16 v[176:191], v[228:231], v[28:31], v[176:191]
    v_cvt_pk_bf16_f32 v12, v200, v201
    v_cvt_pk_bf16_f32 v13, v202, v203
    v_cvt_pk_bf16_f32 v14, v204, v205
    v_cvt_pk_bf16_f32 v15, v206, v207
    v_mfma_f32_32x32x16_bf16 v[192:207], v[224:227], v[32:35], v[160:175]
    v_cvt_pk_bf16_f32 v16, v208, v209
    v_cvt_pk_bf16_f32 v17, v210, v211
    v_cvt_pk_bf16_f32 v18, v212, v213
    v_cvt_pk_bf16_f32 v19, v214, v215
    v_mfma_f32_32x32x16_bf16 v[192:207], v[228:231], v[36:39], v[192:207]
    v_cvt_pk_bf16_f32 v20, v216, v217
    v_cvt_pk_bf16_f32 v21, v218, v219
    v_cvt_pk_bf16_f32 v22, v220, v221
    v_cvt_pk_bf16_f32 v23, v222, v223
    v_mfma_f32_32x32x16_bf16 v[208:223], v[224:227], v[40:43], v[160:175]
    v_cvt_pk_bf16_f32 v24, v176, v177
    v_cvt_pk_bf16_f32 v25, v178, v179
    v_cvt_pk_bf16_f32 v26, v180, v181
    v_cvt_pk_bf16_f32 v27, v182, v183
    v_mfma_f32_32x32x16_bf16 v[208:223], v[228:231], v[44:47], v[208:223]
    v_cvt_pk_bf16_f32 v28, v184, v185
    v_cvt_pk_bf16_f32 v29, v186, v187
    v_cvt_pk_bf16_f32 v30, v188, v189
    v_cvt_pk_bf16_f32 v31, v190, v191
    v_mfma_f32_32x32x16_bf16 v[176:191], v[224:227], v[48:51], v[160:175]
    v_cvt_pk_bf16_f32 v32, v192, v193
    v_cvt_pk_bf16_f32 v33, v194, v195
    v_cvt_pk_bf16_f32 v34, v196, v197
    v_cvt_pk_bf16_f32 v35, v198, v199
    v_mfma_f32_32x32x16_bf16 v[176:191], v[228:231], v[52:55], v[176:191]
    v_cvt_pk_bf16_f32 v36, v200, v201
    v_cvt_pk_bf16_f32 v37, v202, v203
    v_cvt_pk_bf16_f32 v38, v204, v205
    v_cvt_pk_bf16_f32 v39, v206, v207
    v_mfma_f32_32x32x16_bf16 v[192:207], v[224:227], v[56:59], v[160:175]
    v_cvt_pk_bf16_f32 v40, v208, v209
    v_cvt_pk_bf16_f32 v41, v210, v211
    v_cvt_pk_bf16_f32 v42, v212, v213
    v_cvt_pk_bf16_f32 v43, v214, v215
    v_mfma_f32_32x32x16_bf16 v[192:207], v[228:231], v[60:63], v[192:207]
    v_cvt_pk_bf16_f32 v44, v216, v217
    v_cvt_pk_bf16_f32 v45, v218, v219
    v_cvt_pk_bf16_f32 v46, v220, v221
    v_cvt_pk_bf16_f32 v47, v222, v223
    v_mfma_f32_32x32x16_bf16 v[208:223], v[224:227], v[64:67], v[160:175]
    v_cvt_pk_bf16_f32 v48, v176, v177
    v_cvt_pk_bf16_f32 v49, v178, v179
    v_cvt_pk_bf16_f32 v50, v180, v181
    v_cvt_pk_bf16_f32 v51, v182, v183
    v_mfma_f32_32x32x16_bf16 v[208:223], v[228:231], v[68:71], v[208:223]
    v_cvt_pk_bf16_f32 v52, v184, v185
    v_cvt_pk_bf16_f32 v53, v186, v187
    v_cvt_pk_bf16_f32 v54, v188, v189
    v_cvt_pk_bf16_f32 v55, v190, v191
    v_mfma_f32_32x32x16_bf16 v[176:191], v[224:227], v[72:75], v[160:175]
    v_cvt_pk_bf16_f32 v56, v192, v193
    v_cvt_pk_bf16_f32 v57, v194, v195
    v_cvt_pk_bf16_f32 v58, v196, v197
    v_cvt_pk_bf16_f32 v59, v198, v199
    v_mfma_f32_32x32x16_bf16 v[176:191], v[228:231], v[76:79], v[176:191]
    v_cvt_pk_bf16_f32 v60, v200, v201
    v_cvt_pk_bf16_f32 v61, v202, v203
    v_cvt_pk_bf16_f32 v62, v204, v205
    v_cvt_pk_bf16_f32 v63, v206, v207
    v_mfma_f32_32x32x16_bf16 v[192:207], v[224:227], v[80:83], v[160:175]
    v_cvt_pk_bf16_f32 v64, v208, v209
    v_cvt_pk_bf16_f32 v65, v210, v211
    v_cvt_pk_bf16_f32 v66, v212, v213
    v_cvt_pk_bf16_f32 v67, v214, v215
    v_mfma_f32_32x32x16_bf16 v[192:207], v[228:231], v[84:87], v[192:207]
    v_cvt_pk_bf16_f32 v68, v216, v217
    v_cvt_pk_bf16_f32 v69, v218, v219
    v_cvt_pk_bf16_f32 v70, v220, v221
    v_cvt_pk_bf16_f32 v71, v222, v223
    v_mfma_f32_32x32x16_bf16 v[208:223], v[224:227], v[88:91], v[160:175]
    v_cvt_pk_bf16_f32 v72, v176, v177
    v_cvt_pk_bf16_f32 v73, v178, v179
    v_cvt_pk_bf16_f32 v74, v180, v181
    v_cvt_pk_bf16_f32 v75, v182, v183
    v_mfma_f32_32x32x16_bf16 v[208:223], v[228:231], v[92:95], v[208:223]
    v_cvt_pk_bf16_f32 v76, v184, v185
    v_cvt_pk_bf16_f32 v77, v186, v187
    v_cvt_pk_bf16_f32 v78, v188, v189
    v_cvt_pk_bf16_f32 v79, v190, v191
    v_mfma_f32_32x32x16_bf16 v[176:191], v[224:227], v[96:99], v[160:175]
    v_cvt_pk_bf16_f32 v80, v192, v193
    v_cvt_pk_bf16_f32 v81, v194, v195
    v_cvt_pk_bf16_f32 v82, v196, v197
    v_cvt_pk_bf16_f32 v83, v198, v199
    v_mfma_f32_32x32x16_bf16 v[176:191], v[228:231], v[100:103], v[176:191]
    v_cvt_pk_bf16_f32 v84, v200, v201
    v_cvt_pk_bf16_f32 v85, v202, v203
    v_cvt_pk_bf16_f32 v86, v204, v205
    v_cvt_pk_bf16_f32 v87, v206, v207
    v_mfma_f32_32x32x16_bf16 v[192:207], v[224:227], v[104:107], v[160:175]
    v_cvt_pk_bf16_f32 v88, v208, v209
    v_cvt_pk_bf16_f32 v89, v210, v211
    v_cvt_pk_bf16_f32 v90, v212, v213
    v_cvt_pk_bf16_f32 v91, v214, v215
    v_mfma_f32_32x32x16_bf16 v[192:207], v[228:231], v[108:111], v[192:207]
    v_cvt_pk_bf16_f32 v92, v216, v217
    v_cvt_pk_bf16_f32 v93, v218, v219
    v_cvt_pk_bf16_f32 v94, v220, v221
    v_cvt_pk_bf16_f32 v95, v222, v223
    v_cvt_pk_bf16_f32 v96, v176, v177
    v_cvt_pk_bf16_f32 v97, v178, v179
    v_cvt_pk_bf16_f32 v98, v180, v181
    v_cvt_pk_bf16_f32 v99, v182, v183
    v_cvt_pk_bf16_f32 v100, v184, v185
    v_cvt_pk_bf16_f32 v101, v186, v187
    v_cvt_pk_bf16_f32 v102, v188, v189
    v_cvt_pk_bf16_f32 v103, v190, v191
    v_cvt_pk_bf16_f32 v104, v192, v193
    v_cvt_pk_bf16_f32 v105, v194, v195
    v_cvt_pk_bf16_f32 v106, v196, v197
    v_cvt_pk_bf16_f32 v107, v198, v199
    v_cvt_pk_bf16_f32 v108, v200, v201
    v_cvt_pk_bf16_f32 v109, v202, v203
    v_cvt_pk_bf16_f32 v110, v204, v205
    v_cvt_pk_bf16_f32 v111, v206, v207
    s_barrier
    s_lshl_b32 s50, s40, 2
    s_add_u32 s50, s50, s43
    s_lshl_b32 s50, s50, 12
    s_cmp_eq_u32 s41, 15
    s_cbranch_scc1 L_vepi
    ds_read_b64_tr_b16 v[224:225], v248 offset:16384
    ds_read_b64_tr_b16 v[226:227], v248 offset:16640
    ds_read_b64_tr_b16 v[228:229], v248 offset:17408
    ds_read_b64_tr_b16 v[230:231], v248 offset:17664
    ds_read_b64_tr_b16 v[232:233], v248 offset:18432
    ds_read_b64_tr_b16 v[234:235], v248 offset:18688
    ds_read_b64_tr_b16 v[236:237], v248 offset:19456
    ds_read_b64_tr_b16 v[238:239], v248 offset:19712
    ds_read_b64_tr_b16 v[208:209], v248 offset:20480
    ds_read_b64_tr_b16 v[210:211], v248 offset:20736
    ds_read_b64_tr_b16 v[212:213], v248 offset:21504
    ds_read_b64_tr_b16 v[214:215], v248 offset:21760
    s_waitcnt lgkmcnt(10)
    v_mfma_f32_32x32x16_bf16 v[128:143], v[224:227], v[0:3], 0
    ds_read_b64_tr_b16 v[216:217], v248 offset:22528
    ds_read_b64_tr_b16 v[218:219], v248 offset:22784
    s_waitcnt lgkmcnt(10)
    v_mfma_f32_32x32x16_bf16 v[128:143], v[228:231], v[4:7], v[128:143]
    ds_read_b64_tr_b16 v[224:225], v248 offset:23552
    ds_read_b64_tr_b16 v[226:227], v248 offset:23808
    s_waitcnt lgkmcnt(10)
    v_mfma_f32_32x32x16_bf16 v[128:143], v[232:235], v[8:11], v[128:143]
    ds_read_b64_tr_b16 v[228:229], v248 offset:24576
    ds_read_b64_tr_b16 v[230:231], v248 offset:24832
    s_waitcnt lgkmcnt(10)
    v_mfma_f32_32x32x16_bf16 v[128:143], v[236:239], v[12:15], v[128:143]
    ds_read_b64_tr_b16 v[232:233], v248 offset:25600
    ds_read_b64_tr_b16 v[234:235], v248 offset:25856
    s_waitcnt lgkmcnt(10)
    v_mfma_f32_32x32x16_bf16 v[128:143], v[208:211], v[16:19], v[128:143]
    ds_read_b64_tr_b16 v[236:237], v248 offset:26624
    ds_read_b64_tr_b16 v[238:239], v248 offset:26880
    s_waitcnt lgkmcnt(10)
    v_mfma_f32_32x32x16_bf16 v[128:143], v[212:215], v[20:23], v[128:143]
    ds_read_b64_tr_b16 v[208:209], v248 offset:27648
    ds_read_b64_tr_b16 v[210:211], v248 offset:27904
    s_waitcnt lgkmcnt(10)
    v_mfma_f32_32x32x16_bf16 v[128:143], v[216:219], v[24:27], v[128:143]
    ds_read_b64_tr_b16 v[212:213], v248 offset:28672
    ds_read_b64_tr_b16 v[214:215], v248 offset:28928
    s_waitcnt lgkmcnt(10)
    v_mfma_f32_32x32x16_bf16 v[128:143], v[224:227], v[28:31], v[128:143]
    ds_read_b64_tr_b16 v[216:217], v248 offset:29696
    ds_read_b64_tr_b16 v[218:219], v248 offset:29952
    s_waitcnt lgkmcnt(10)
    v_mfma_f32_32x32x16_bf16 v[128:143], v[228:231], v[32:35], v[128:143]
    ds_read_b64_tr_b16 v[224:225], v248 offset:30720
    ds_read_b64_tr_b16 v[226:227], v248 offset:30976
    s_waitcnt lgkmcnt(10)
    v_mfma_f32_32x32x16_bf16 v[128:143], v[232:235], v[36:39], v[128:143]
    ds_read_b64_tr_b16 v[228:229], v248 offset:31744
    ds_read_b64_tr_b16 v[230:231], v248 offset:32000
    s_waitcnt lgkmcnt(10)
    v_mfma_f32_32x32x16_bf16 v[128:143], v[236:239], v[40:43], v[128:143]
    ds_read_b64_tr_b16 v[232:233], v248 offset:32768
    ds_read_b64_tr_b16 v[234:235], v248 offset:33024
    s_waitcnt lgkmcnt(10)
    v_mfma_f32_32x32x16_bf16 v[128:143], v[208:211], v[44:47], v[128:143]
    ds_read_b64_tr_b16 v[236:237], v248 offset:33792
    ds_read_b64_tr_b16 v[238:239], v248 offset:34048
    s_waitcnt lgkmcnt(10)
    v_mfma_f32_32x32x16_bf16 v[128:143], v[212:215], v[48:51], v[128:143]
    ds_read_b64_tr_b16 v[208:209], v248 offset:34816
    ds_read_b64_tr_b16 v[210:211], v248 offset:35072
    s_waitcnt lgkmcnt(10)
    v_mfma_f32_32x32x16_bf16 v[128:143], v[216:219], v[52:55], v[128:143]
    ds_read_b64_tr_b16 v[212:213], v248 offset:35840
    ds_read_b64_tr_b16 v[214:215], v248 offset:36096
    s_waitcnt lgkmcnt(10)
    v_mfma_f32_32x32x16_bf16 v[128:143], v[224:227], v[56:59], v[128:143]
    ds_read_b64_tr_b16 v[216:217], v248 offset:36864
    ds_read_b64_tr_b16 v[218:219], v248 offset:37120
    s_waitcnt lgkmcnt(10)
    v_mfma_f32_32x32x16_bf16 v[128:143], v[228:231], v[60:63], v[128:143]
    ds_read_b64_tr_b16 v[224:225], v248 offset:37888
    ds_read_b64_tr_b16 v[226:227], v248 offset:38144
    s_waitcnt lgkmcnt(10)
    v_mfma_f32_32x32x16_bf16 v[128:143], v[232:235], v[64:67], v[128:143]
    ds_read_b64_tr_b16 v[228:229], v248 offset:38912
    ds_read_b64_tr_b16 v[230:231], v248 offset:39168
    s_waitcnt lgkmcnt(10)
    v_mfma_f32_32x32x16_bf16 v[128:143], v[236:239], v[68:71], v[128:143]
    ds_read_b64_tr_b16 v[232:233], v248 offset:39936
    ds_read_b64_tr_b16 v[234:235], v248 offset:40192
    s_waitcnt lgkmcnt(10)
    v_mfma_f32_32x32x16_bf16 v[128:143], v[208:211], v[72:75], v[128:143]
    ds_read_b64_tr_b16 v[236:237], v248 offset:40960
    ds_read_b64_tr_b16 v[238:239], v248 offset:41216
    s_waitcnt lgkmcnt(10)
    v_mfma_f32_32x32x16_bf16 v[128:143], v[212:215], v[76:79], v[128:143]
    ds_read_b64_tr_b16 v[208:209], v248 offset:41984
    ds_read_b64_tr_b16 v[210:211], v248 offset:42240
    s_waitcnt lgkmcnt(10)
    v_mfma_f32_32x32x16_bf16 v[128:143], v[216:219], v[80:83], v[128:143]
    ds_read_b64_tr_b16 v[212:213], v248 offset:43008
    ds_read_b64_tr_b16 v[214:215], v248 offset:43264
    s_waitcnt lgkmcnt(10)
    v_mfma_f32_32x32x16_bf16 v[128:143], v[224:227], v[84:87], v[128:143]
    ds_read_b64_tr_b16 v[216:217], v248 offset:44032
    ds_read_b64_tr_b16 v[218:219], v248 offset:44288
    s_waitcnt lgkmcnt(10)
    v_mfma_f32_32x32x16_bf16 v[128:143], v[228:231], v[88:91], v[128:143]
    s_waitcnt lgkmcnt(8)
    v_mfma_f32_32x32x16_bf16 v[128:143], v[232:235], v[92:95], v[128:143]
    s_waitcnt lgkmcnt(6)
    v_mfma_f32_32x32x16_bf16 v[128:143], v[236:239], v[96:99], v[128:143]
    s_waitcnt lgkmcnt(4)
    v_mfma_f32_32x32x16_bf16 v[128:143], v[208:211], v[100:103], v[128:143]
    s_waitcnt lgkmcnt(2)
    v_mfma_f32_32x32x16_bf16 v[128:143], v[212:215], v[104:107], v[128:143]
    s_waitcnt lgkmcnt(0)
    v_mfma_f32_32x32x16_bf16 v[128:143], v[216:219], v[108:111], v[128:143]
    v_cmp_gt_u32 vcc, 32, v255
    v_bfe_u32 v193, v255, 2, 1
    v_bfe_u32 v194, v255, 3, 1
    v_cndmask_b32 v192, 0, v253, vcc
    v_xor_b32 v193, v193, v194
    v_mul_u32_u24 v193, 12, v193
    v_xor_b32 v193, v193, v255
    v_lshlrev_b32 v193, 4, v193
    s_nop 3
    v_mul_f32 v128, v253, v128
    v_mul_f32 v129, v253, v129
    v_mul_f32 v130, v253, v130
    v_mul_f32 v131, v253, v131
    v_mul_f32 v132, v253, v132
    v_mul_f32 v133, v253, v133
    v_mul_f32 v134, v253, v134
    v_mul_f32 v135, v253, v135
    v_mul_f32 v136, v253, v136
    v_mul_f32 v137, v253, v137
    v_mul_f32 v138, v253, v138
    v_mul_f32 v139, v253, v139
    v_mul_f32 v140, v192, v140
    v_mul_f32 v141, v192, v141
    v_mul_f32 v142, v192, v142
    v_mul_f32 v143, v192, v143
    v_cvt_pk_bf16_f32 v128, v128, v129
    v_cvt_pk_bf16_f32 v129, v130, v131
    v_cvt_pk_bf16_f32 v130, v132, v133
    v_cvt_pk_bf16_f32 v131, v134, v135
    v_cvt_pk_bf16_f32 v132, v136, v137
    v_cvt_pk_bf16_f32 v133, v138, v139
    v_cvt_pk_bf16_f32 v134, v140, v141
    v_cvt_pk_bf16_f32 v135, v142, v143
    buffer_store_dwordx4 v[128:131], v193, s[20:23], s50 offen sc1
    buffer_store_dwordx4 v[132:135], v193, s[20:23], s50 offen offset:1024 sc1
    s_branch L_kvdone
L_vepi:
    s_lshl_b32 s51, s43, 7
    s_add_u32 s51, s51, 0
    v_and_b32 v192, 31, v255
    v_lshl_add_u32 v193, v192, 2, s51
    ds_write_b32 v193, v253
    v_lshrrev_b32 v193, 5, v255
    v_lshl_add_u32 v193, v193, 4, s51
    s_waitcnt lgkmcnt(0)
    ds_read_b128 v[160:163], v193 offset:0
    ds_read_b128 v[164:167], v193 offset:32
    ds_read_b128 v[168:171], v193 offset:64
    ds_read_b128 v[172:175], v193 offset:96
    v_cmp_eq_u32 vcc, 28, v192
    v_mov_b32 v194, 0x3f803f80
    s_nop 0
    v_cndmask_b32 v194, 0, v194, vcc
    v_cmp_gt_u32 vcc, 28, v192
    ds_read_b64_tr_b16 v[224:225], v248 offset:16384
    ds_read_b64_tr_b16 v[226:227], v248 offset:16640
    ds_read_b64_tr_b16 v[228:229], v248 offset:17408
    ds_read_b64_tr_b16 v[230:231], v248 offset:17664
    ds_read_b64_tr_b16 v[232:233], v248 offset:18432
    ds_read_b64_tr_b16 v[234:235], v248 offset:18688
    ds_read_b64_tr_b16 v[236:237], v248 offset:19456
    ds_read_b64_tr_b16 v[238:239], v248 offset:19712
    ds_read_b64_tr_b16 v[208:209], v248 offset:20480
    ds_read_b64_tr_b16 v[210:211], v248 offset:20736
    ds_read_b64_tr_b16 v[212:213], v248 offset:21504
    ds_read_b64_tr_b16 v[214:215], v248 offset:21760
    s_waitcnt lgkmcnt(10)
    v_mfma_f32_32x32x16_bf16 v[144:159], v[0:3], v[224:227], 0
    ds_read_b64_tr_b16 v[216:217], v248 offset:22528
    ds_read_b64_tr_b16 v[218:219], v248 offset:22784
    s_waitcnt lgkmcnt(10)
    v_mfma_f32_32x32x16_bf16 v[144:159], v[4:7], v[228:231], v[144:159]
    ds_read_b64_tr_b16 v[224:225], v248 offset:23552
    ds_read_b64_tr_b16 v[226:227], v248 offset:23808
    s_waitcnt lgkmcnt(10)
    v_mfma_f32_32x32x16_bf16 v[144:159], v[8:11], v[232:235], v[144:159]
    ds_read_b64_tr_b16 v[228:229], v248 offset:24576
    ds_read_b64_tr_b16 v[230:231], v248 offset:24832
    s_waitcnt lgkmcnt(10)
    v_mfma_f32_32x32x16_bf16 v[144:159], v[12:15], v[236:239], v[144:159]
    ds_read_b64_tr_b16 v[232:233], v248 offset:25600
    ds_read_b64_tr_b16 v[234:235], v248 offset:25856
    s_waitcnt lgkmcnt(10)
    v_mfma_f32_32x32x16_bf16 v[144:159], v[16:19], v[208:211], v[144:159]
    ds_read_b64_tr_b16 v[236:237], v248 offset:26624
    ds_read_b64_tr_b16 v[238:239], v248 offset:26880
    s_waitcnt lgkmcnt(10)
    v_mfma_f32_32x32x16_bf16 v[144:159], v[20:23], v[212:215], v[144:159]
    ds_read_b64_tr_b16 v[208:209], v248 offset:27648
    ds_read_b64_tr_b16 v[210:211], v248 offset:27904
    s_waitcnt lgkmcnt(10)
    v_mfma_f32_32x32x16_bf16 v[144:159], v[24:27], v[216:219], v[144:159]
    ds_read_b64_tr_b16 v[212:213], v248 offset:28672
    ds_read_b64_tr_b16 v[214:215], v248 offset:28928
    s_waitcnt lgkmcnt(10)
    v_mfma_f32_32x32x16_bf16 v[144:159], v[28:31], v[224:227], v[144:159]
    ds_read_b64_tr_b16 v[216:217], v248 offset:29696
    ds_read_b64_tr_b16 v[218:219], v248 offset:29952
    s_waitcnt lgkmcnt(10)
    v_mfma_f32_32x32x16_bf16 v[144:159], v[32:35], v[228:231], v[144:159]
    ds_read_b64_tr_b16 v[224:225], v248 offset:30720
    ds_read_b64_tr_b16 v[226:227], v248 offset:30976
    s_waitcnt lgkmcnt(10)
    v_mfma_f32_32x32x16_bf16 v[144:159], v[36:39], v[232:235], v[144:159]
    ds_read_b64_tr_b16 v[228:229], v248 offset:31744
    ds_read_b64_tr_b16 v[230:231], v248 offset:32000
    s_waitcnt lgkmcnt(10)
    v_mfma_f32_32x32x16_bf16 v[144:159], v[40:43], v[236:239], v[144:159]
    ds_read_b64_tr_b16 v[232:233], v248 offset:32768
    ds_read_b64_tr_b16 v[234:235], v248 offset:33024
    s_waitcnt lgkmcnt(10)
    v_mfma_f32_32x32x16_bf16 v[144:159], v[44:47], v[208:211], v[144:159]
    ds_read_b64_tr_b16 v[236:237], v248 offset:33792
    ds_read_b64_tr_b16 v[238:239], v248 offset:34048
    s_waitcnt lgkmcnt(10)
    v_mfma_f32_32x32x16_bf16 v[144:159], v[48:51], v[212:215], v[144:159]
    ds_read_b64_tr_b16 v[208:209], v248 offset:34816
    ds_read_b64_tr_b16 v[210:211], v248 offset:35072
    s_waitcnt lgkmcnt(10)
    v_mfma_f32_32x32x16_bf16 v[144:159], v[52:55], v[216:219], v[144:159]
    ds_read_b64_tr_b16 v[212:213], v248 offset:35840
    ds_read_b64_tr_b16 v[214:215], v248 offset:36096
    s_waitcnt lgkmcnt(10)
    v_mfma_f32_32x32x16_bf16 v[144:159], v[56:59], v[224:227], v[144:159]
    ds_read_b64_tr_b16 v[216:217], v248 offset:36864
    ds_read_b64_tr_b16 v[218:219], v248 offset:37120
    s_waitcnt lgkmcnt(10)
    v_mfma_f32_32x32x16_bf16 v[144:159], v[60:63], v[228:231], v[144:159]
    ds_read_b64_tr_b16 v[224:225], v248 offset:37888
    ds_read_b64_tr_b16 v[226:227], v248 offset:38144
    s_waitcnt lgkmcnt(10)
    v_mfma_f32_32x32x16_bf16 v[144:159], v[64:67], v[232:235], v[144:159]
    ds_read_b64_tr_b16 v[228:229], v248 offset:38912
    ds_read_b64_tr_b16 v[230:231], v248 offset:39168
    s_waitcnt lgkmcnt(10)
    v_mfma_f32_32x32x16_bf16 v[144:159], v[68:71], v[236:239], v[144:159]
    ds_read_b64_tr_b16 v[232:233], v248 offset:39936
    ds_read_b64_tr_b16 v[234:235], v248 offset:40192
    s_waitcnt lgkmcnt(10)
    v_mfma_f32_32x32x16_bf16 v[144:159], v[72:75], v[208:211], v[144:159]
    ds_read_b64_tr_b16 v[236:237], v248 offset:40960
    ds_read_b64_tr_b16 v[238:239], v248 offset:41216
    s_waitcnt lgkmcnt(10)
    v_mfma_f32_32x32x16_bf16 v[144:159], v[76:79], v[212:215], v[144:159]
    ds_read_b64_tr_b16 v[208:209], v248 offset:41984
    ds_read_b64_tr_b16 v[210:211], v248 offset:42240
    s_waitcnt lgkmcnt(10)
    v_mfma_f32_32x32x16_bf16 v[144:159], v[80:83], v[216:219], v[144:159]
    ds_read_b64_tr_b16 v[212:213], v248 offset:43008
    ds_read_b64_tr_b16 v[214:215], v248 offset:43264
    s_waitcnt lgkmcnt(10)
    v_mfma_f32_32x32x16_bf16 v[144:159], v[84:87], v[224:227], v[144:159]
    ds_read_b64_tr_b16 v[216:217], v248 offset:44032
    ds_read_b64_tr_b16 v[218:219], v248 offset:44288
    s_waitcnt lgkmcnt(10)
    v_mfma_f32_32x32x16_bf16 v[144:159], v[88:91], v[228:231], v[144:159]
    s_waitcnt lgkmcnt(8)
    v_mfma_f32_32x32x16_bf16 v[144:159], v[92:95], v[232:235], v[144:159]
    s_waitcnt lgkmcnt(6)
    v_mfma_f32_32x32x16_bf16 v[144:159], v[96:99], v[236:239], v[144:159]
    s_waitcnt lgkmcnt(4)
    v_mfma_f32_32x32x16_bf16 v[144:159], v[100:103], v[208:211], v[144:159]
    s_waitcnt lgkmcnt(2)
    v_mfma_f32_32x32x16_bf16 v[144:159], v[104:107], v[212:215], v[144:159]
    s_waitcnt lgkmcnt(0)
    v_mfma_f32_32x32x16_bf16 v[144:159], v[108:111], v[216:219], v[144:159]
    s_nop 11
    v_mul_f32 v144, v160, v144
    v_mul_f32 v145, v161, v145
    v_mul_f32 v146, v162, v146
    v_mul_f32 v147, v163, v147
    v_mul_f32 v148, v164, v148
    v_mul_f32 v149, v165, v149
    v_mul_f32 v150, v166, v150
    v_mul_f32 v151, v167, v151
    v_mul_f32 v152, v168, v152
    v_mul_f32 v153, v169, v153
    v_mul_f32 v154, v170, v154
    v_mul_f32 v155, v171, v155
    v_mul_f32 v156, v172, v156
    v_mul_f32 v157, v173, v157
    v_mul_f32 v158, v174, v158
    v_mul_f32 v159, v175, v159
    v_cvt_pk_bf16_f32 v144, v144, v145
    v_cvt_pk_bf16_f32 v145, v146, v147
    v_cvt_pk_bf16_f32 v146, v148, v149
    v_cvt_pk_bf16_f32 v147, v150, v151
    v_cvt_pk_bf16_f32 v148, v152, v153
    v_cvt_pk_bf16_f32 v149, v154, v155
    v_cvt_pk_bf16_f32 v150, v156, v157
    v_cvt_pk_bf16_f32 v151, v158, v159
    v_cndmask_b32 v144, v194, v144, vcc
    v_cndmask_b32 v145, v194, v145, vcc
    v_cndmask_b32 v146, v194, v146, vcc
    v_cndmask_b32 v147, v194, v147, vcc
    v_cndmask_b32 v148, v194, v148, vcc
    v_cndmask_b32 v149, v194, v149, vcc
    v_cndmask_b32 v150, v194, v150, vcc
    v_cndmask_b32 v151, v194, v151, vcc
    buffer_store_dwordx4 v[144:147], v244, s[20:23], s50 offen offset:2048 sc1
    buffer_store_dwordx4 v[148:151], v244, s[20:23], s50 offen offset:3072 sc1
L_kvdone:
    s_waitcnt vmcnt(0)
    s_barrier
    ds_read_b64_tr_b16 v[224:225], v248 offset:45056
    ds_read_b64_tr_b16 v[226:227], v248 offset:45312
    ds_read_b64_tr_b16 v[228:229], v248 offset:46080
    ds_read_b64_tr_b16 v[230:231], v248 offset:46336
    ds_read_b64_tr_b16 v[232:233], v248 offset:47104
    ds_read_b64_tr_b16 v[234:235], v248 offset:47360
    ds_read_b64_tr_b16 v[236:237], v248 offset:48128
    ds_read_b64_tr_b16 v[238:239], v248 offset:48384
    ds_read_b64_tr_b16 v[208:209], v248 offset:49152
    ds_read_b64_tr_b16 v[210:211], v248 offset:49408
    ds_read_b64_tr_b16 v[212:213], v248 offset:50176
    ds_read_b64_tr_b16 v[214:215], v248 offset:50432
    s_waitcnt lgkmcnt(10)
    v_mfma_f32_32x32x16_bf16 v[112:127], v[224:227], v[0:3], 0
    ds_read_b64_tr_b16 v[216:217], v248 offset:51200
    ds_read_b64_tr_b16 v[218:219], v248 offset:51456
    s_waitcnt lgkmcnt(10)
    v_mfma_f32_32x32x16_bf16 v[112:127], v[228:231], v[4:7], v[112:127]
    ds_read_b64_tr_b16 v[224:225], v248 offset:52224
    ds_read_b64_tr_b16 v[226:227], v248 offset:52480
    s_waitcnt lgkmcnt(10)
    v_mfma_f32_32x32x16_bf16 v[112:127], v[232:235], v[8:11], v[112:127]
    ds_read_b64_tr_b16 v[228:229], v248 offset:53248
    ds_read_b64_tr_b16 v[230:231], v248 offset:53504
    s_waitcnt lgkmcnt(10)
    v_mfma_f32_32x32x16_bf16 v[112:127], v[236:239], v[12:15], v[112:127]
    ds_read_b64_tr_b16 v[232:233], v248 offset:54272
    ds_read_b64_tr_b16 v[234:235], v248 offset:54528
    s_waitcnt lgkmcnt(10)
    v_mfma_f32_32x32x16_bf16 v[112:127], v[208:211], v[16:19], v[112:127]
    ds_read_b64_tr_b16 v[236:237], v248 offset:55296
    ds_read_b64_tr_b16 v[238:239], v248 offset:55552
    s_waitcnt lgkmcnt(10)
    v_mfma_f32_32x32x16_bf16 v[112:127], v[212:215], v[20:23], v[112:127]
    ds_read_b64_tr_b16 v[208:209], v248 offset:56320
    ds_read_b64_tr_b16 v[210:211], v248 offset:56576
    s_waitcnt lgkmcnt(10)
    v_mfma_f32_32x32x16_bf16 v[112:127], v[216:219], v[24:27], v[112:127]
    ds_read_b64_tr_b16 v[212:213], v248 offset:57344
    ds_read_b64_tr_b16 v[214:215], v248 offset:57600
    s_waitcnt lgkmcnt(10)
    v_mfma_f32_32x32x16_bf16 v[112:127], v[224:227], v[28:31], v[112:127]
    ds_read_b64_tr_b16 v[216:217], v248 offset:58368
    ds_read_b64_tr_b16 v[218:219], v248 offset:58624
    s_waitcnt lgkmcnt(10)
    v_mfma_f32_32x32x16_bf16 v[112:127], v[228:231], v[32:35], v[112:127]
    ds_read_b64_tr_b16 v[224:225], v248 offset:59392
    ds_read_b64_tr_b16 v[226:227], v248 offset:59648
    s_waitcnt lgkmcnt(10)
    v_mfma_f32_32x32x16_bf16 v[112:127], v[232:235], v[36:39], v[112:127]
    ds_read_b64_tr_b16 v[228:229], v248 offset:60416
    ds_read_b64_tr_b16 v[230:231], v248 offset:60672
    s_waitcnt lgkmcnt(10)
    v_mfma_f32_32x32x16_bf16 v[112:127], v[236:239], v[40:43], v[112:127]
    ds_read_b64_tr_b16 v[232:233], v248 offset:61440
    ds_read_b64_tr_b16 v[234:235], v248 offset:61696
    s_waitcnt lgkmcnt(10)
    v_mfma_f32_32x32x16_bf16 v[112:127], v[208:211], v[44:47], v[112:127]
    ds_read_b64_tr_b16 v[236:237], v248 offset:62464
    ds_read_b64_tr_b16 v[238:239], v248 offset:62720
    s_waitcnt lgkmcnt(10)
    v_mfma_f32_32x32x16_bf16 v[112:127], v[212:215], v[48:51], v[112:127]
    ds_read_b64_tr_b16 v[208:209], v248 offset:63488
    ds_read_b64_tr_b16 v[210:211], v248 offset:63744
    s_waitcnt lgkmcnt(10)
    v_mfma_f32_32x32x16_bf16 v[112:127], v[216:219], v[52:55], v[112:127]
    ds_read_b64_tr_b16 v[212:213], v248 offset:64512
    ds_read_b64_tr_b16 v[214:215], v248 offset:64768
    s_waitcnt lgkmcnt(10)
    v_mfma_f32_32x32x16_bf16 v[112:127], v[224:227], v[56:59], v[112:127]
    ds_read_b64_tr_b16 v[216:217], v248 offset:0
    ds_read_b64_tr_b16 v[218:219], v248 offset:256
    s_waitcnt lgkmcnt(10)
    v_mfma_f32_32x32x16_bf16 v[112:127], v[228:231], v[60:63], v[112:127]
    ds_read_b64_tr_b16 v[224:225], v248 offset:1024
    ds_read_b64_tr_b16 v[226:227], v248 offset:1280
    s_waitcnt lgkmcnt(10)
    v_mfma_f32_32x32x16_bf16 v[112:127], v[232:235], v[64:67], v[112:127]
    ds_read_b64_tr_b16 v[228:229], v248 offset:2048
    ds_read_b64_tr_b16 v[230:231], v248 offset:2304
    s_waitcnt lgkmcnt(10)
    v_mfma_f32_32x32x16_bf16 v[112:127], v[236:239], v[68:71], v[112:127]
    ds_read_b64_tr_b16 v[232:233], v248 offset:3072
    ds_read_b64_tr_b16 v[234:235], v248 offset:3328
    s_waitcnt lgkmcnt(10)
    v_mfma_f32_32x32x16_bf16 v[112:127], v[208:211], v[72:75], v[112:127]
    ds_read_b64_tr_b16 v[236:237], v248 offset:4096
    ds_read_b64_tr_b16 v[238:239], v248 offset:4352
    s_waitcnt lgkmcnt(10)
    v_mfma_f32_32x32x16_bf16 v[112:127], v[212:215], v[76:79], v[112:127]
    ds_read_b64_tr_b16 v[208:209], v248 offset:5120
    ds_read_b64_tr_b16 v[210:211], v248 offset:5376
    s_waitcnt lgkmcnt(10)
    v_mfma_f32_32x32x16_bf16 v[112:127], v[216:219], v[80:83], v[112:127]
    ds_read_b64_tr_b16 v[212:213], v248 offset:6144
    ds_read_b64_tr_b16 v[214:215], v248 offset:6400
    s_waitcnt lgkmcnt(10)
    v_mfma_f32_32x32x16_bf16 v[112:127], v[224:227], v[84:87], v[112:127]
    ds_read_b64_tr_b16 v[216:217], v248 offset:7168
    ds_read_b64_tr_b16 v[218:219], v248 offset:7424
    s_waitcnt lgkmcnt(10)
    v_mfma_f32_32x32x16_bf16 v[112:127], v[228:231], v[88:91], v[112:127]
    s_waitcnt lgkmcnt(8)
    v_mfma_f32_32x32x16_bf16 v[112:127], v[232:235], v[92:95], v[112:127]
    s_waitcnt lgkmcnt(6)
    v_mfma_f32_32x32x16_bf16 v[112:127], v[236:239], v[96:99], v[112:127]
    s_waitcnt lgkmcnt(4)
    v_mfma_f32_32x32x16_bf16 v[112:127], v[208:211], v[100:103], v[112:127]
    s_waitcnt lgkmcnt(2)
    v_mfma_f32_32x32x16_bf16 v[112:127], v[212:215], v[104:107], v[112:127]
    s_waitcnt lgkmcnt(0)
    v_mfma_f32_32x32x16_bf16 v[112:127], v[216:219], v[108:111], v[112:127]
    s_nop 11
    v_mul_f32 v112, v249, v112
    v_mul_f32 v113, v249, v113
    v_mul_f32 v114, v249, v114
    v_mul_f32 v115, v249, v115
    v_mul_f32 v116, v249, v116
    v_mul_f32 v117, v249, v117
    v_mul_f32 v118, v249, v118
    v_mul_f32 v119, v249, v119
    v_mul_f32 v120, v249, v120
    v_mul_f32 v121, v249, v121
    v_mul_f32 v122, v249, v122
    v_mul_f32 v123, v249, v123
    v_mul_f32 v124, v249, v124
    v_mul_f32 v125, v249, v125
    v_mul_f32 v126, v249, v126
    v_mul_f32 v127, v249, v127
    v_cvt_pk_bf16_f32 v112, v112, v113
    v_cvt_pk_bf16_f32 v113, v114, v115
    v_cvt_pk_bf16_f32 v114, v116, v117
    v_cvt_pk_bf16_f32 v115, v118, v119
    v_cvt_pk_bf16_f32 v116, v120, v121
    v_cvt_pk_bf16_f32 v117, v122, v123
    v_cvt_pk_bf16_f32 v118, v124, v125
    v_cvt_pk_bf16_f32 v119, v126, v127
    v_add_u32 v120, s49, v244
    ds_write_b128 v120, v[112:115]
    ds_write_b128 v120, v[116:119] offset:1024
    s_waitcnt lgkmcnt(0)
    s_barrier
    s_lshl_b32 s53, s43, 16
    v_add_u32 v160, s53, v244
    s_lshr_b32 s52, s2, 3
    s_lshl_b32 s52, s52, 12
    s_and_b32 s52, s52, 0xffff
    s_add_u32 s53, s43, 1
    s_and_b32 s53, s53, 3
    s_lshl_b32 s53, s53, 11
    s_add_u32 s53, s53, 57344
    v_add_u32 v161, s53, v244
    s_add_u32 s53, s43, 2
    s_and_b32 s53, s53, 3
    s_lshl_b32 s53, s53, 11
    s_add_u32 s53, s53, 57344
    v_add_u32 v162, s53, v244
    s_add_u32 s53, s43, 3
    s_and_b32 s53, s53, 3
    s_lshl_b32 s53, s53, 11
    s_add_u32 s53, s53, 57344
    v_add_u32 v163, s53, v244
    s_add_u32 s53, s43, 4
    s_and_b32 s53, s53, 3
    s_lshl_b32 s53, s53, 11
    s_add_u32 s53, s53, 57344
    v_add_u32 v164, s53, v244
    buffer_load_dwordx4 v[0:3], v160, s[20:23], s52 offen offset:0 sc1
    buffer_load_dwordx4 v[4:7], v160, s[20:23], s52 offen offset:1024 sc1
    s_mov_b32 s56, s52
    s_add_u32 s52, s52, 4096
    s_and_b32 s52, s52, 0xffff
    buffer_load_dwordx4 v[8:11], v160, s[20:23], s56 offen offset:2048 sc1
    buffer_load_dwordx4 v[12:15], v160, s[20:23], s56 offen offset:3072 sc1
    buffer_load_dwordx4 v[16:19], v160, s[20:23], s52 offen offset:0 sc1
    buffer_load_dwordx4 v[20:23], v160, s[20:23], s52 offen offset:1024 sc1
    s_mov_b32 s56, s52
    s_add_u32 s52, s52, 4096
    s_and_b32 s52, s52, 0xffff
    buffer_load_dwordx4 v[24:27], v160, s[20:23], s56 offen offset:2048 sc1
    buffer_load_dwordx4 v[28:31], v160, s[20:23], s56 offen offset:3072 sc1
    ds_read_b128 v[64:67], v161 offset:0
    ds_read_b128 v[68:71], v161 offset:1024
    ds_read_b128 v[72:75], v162 offset:0
    ds_read_b128 v[76:79], v162 offset:1024
    ds_read_b128 v[80:83], v163 offset:0
    ds_read_b128 v[84:87], v163 offset:1024
    ds_read_b128 v[88:91], v164 offset:0
    ds_read_b128 v[92:95], v164 offset:1024
    s_waitcnt vmcnt(0)
    v_mov_b32 v224, 0
    v_mov_b32 v225, 0
    v_mov_b32 v226, 0
    v_mov_b32 v227, 0
    s_lshl_b32 s53, s43, 16
    v_add_u32 v241, s53, v244
    v_mov_b32 v240, 0xdddddddd
    v_lshrrev_b32 v255, 4, v244
    v_mfma_f32_32x32x16_bf16 v[144:159], v[224:227], v[224:227], 0
    v_mfma_f32_32x32x16_bf16 v[160:175], v[224:227], v[224:227], 0
    v_mfma_f32_32x32x16_bf16 v[176:191], v[224:227], v[224:227], 0
    v_mfma_f32_32x32x16_bf16 v[96:111], v[224:227], v[224:227], 0
    s_waitcnt lgkmcnt(0)
    v_mfma_f32_32x32x16_bf16 v[192:207], v[0:3], v[64:67], 0
    v_mfma_f32_32x32x16_bf16 v[192:207], v[4:7], v[68:71], v[192:207]
    s_nop 7
    s_nop 3
    s_branch L_att0
L_B:
    s_mov_b32 s20, s86
    s_mov_b32 s21, s87
    s_mov_b32 s22, 16777216
    s_mov_b32 s23, 0x20000
    s_mov_b32 s12, s66
    s_mov_b32 s13, s67
    s_mov_b32 s14, 401408
    s_mov_b32 s15, 0x20000
    s_mov_b32 s24, s80
    s_mov_b32 s25, s81
    s_mov_b32 s26, 1605632
    s_mov_b32 s27, 0x20000
    s_mov_b32 s28, s72
    s_mov_b32 s29, s73
    s_mov_b32 s30, 401408
    s_mov_b32 s31, 0x20000
    s_mov_b32 s32, s82
    s_mov_b32 s33, s83
    s_mov_b32 s34, 1835008
    s_mov_b32 s35, 0x20000
    s_mov_b32 s36, s84
    s_mov_b32 s37, s85
    s_mov_b32 s38, 256
    s_mov_b32 s39, 0x20000
    s_and_b32 s44, s43, 1
    s_cmp_eq_u32 s44, 1
    s_cselect_b32 s46, s78, s76
    s_cselect_b32 s47, s79, s77
    s_cmp_eq_u32 s41, 15
    s_cselect_b32 s48, s70, s68
    s_cselect_b32 s49, s71, s69
    s_cmp_eq_u32 s101, 7
    s_cselect_b32 s16, s48, s46
    s_cselect_b32 s17, s49, s47
    s_cselect_b32 s18, 25088, s26
    s_mov_b32 s19, 0x20000
    s_cmp_eq_u32 s101, 7
    s_cbranch_scc1 L_BS
    v_lshrrev_b32 v1, 3, v255
    v_mul_u32_u24 v240, 3584, v1
    v_and_b32 v1, 3, v1
    s_and_b32 s44, s43, 1
    v_xor_b32 v1, s44, v1
    v_bfe_u32 v2, v255, 1, 2
    v_xor_b32 v1, v1, v2
    v_lshl_add_u32 v240, v1, 5, v240
    v_and_b32 v1, 1, v255
    v_lshl_add_u32 v240, v1, 4, v240
    v_lshrrev_b32 v1, 2, v255
    v_mul_u32_u24 v241, 896, v1
    v_and_b32 v1, 3, v255
    v_lshl_add_u32 v241, v1, 4, v241
    s_lshr_b32 s45, s43, 1
    s_mul_i32 s50, s45, 28672
    s_lshl_b32 s46, s100, 8
    s_add_u32 s50, s50, s46
    s_mul_i32 s46, s95, 229376
    s_add_u32 s50, s50, s46
    s_lshl_b32 s51, s44, 11
    s_lshl_b32 s45, s45, 10
    s_add_u32 s51, s51, s45
    s_add_u32 s51, s51, 65536
    s_mul_i32 s52, s43, 14336
    s_mul_i32 s46, s41, 56
    s_add_u32 s52, s52, s46
    s_mul_i32 s46, s95, 57344
    s_add_u32 s52, s52, s46
    s_lshl_b32 s53, s43, 10
    s_add_u32 s53, s53, 65536
    s_mov_b32 s96, s95
    s_mov_b32 s97, s95
    s_lshr_b32 s56, s41, 3
    s_mov_b32 s57, s101
    v_lshrrev_b32 v1, 3, v255
    v_mul_u32_u24 v242, 896, v1
    v_bfe_u32 v1, v255, 4, 1
    v_lshlrev_b32 v1, 2, v1
    v_and_b32 v2, 7, v255
    v_xor_b32 v1, v1, v2
    v_lshl_add_u32 v242, v1, 4, v242
    s_lshl_b32 s58, s43, 11
    s_mul_i32 s59, s43, 401408
    s_lshl_b32 s46, s57, 7
    s_add_u32 s59, s59, s46
    s_mul_i32 s60, s43, 100352
    s_add_u32 s60, s60, s46
    v_lshrrev_b32 v1, 5, v255
    v_lshlrev_b32 v243, 9, v1
    v_bfe_u32 v1, v255, 2, 2
    v_lshl_add_u32 v243, v1, 7, v243
    v_bfe_u32 v1, v255, 3, 1
    s_lshr_b32 s46, s43, 1
    v_xor_b32 v1, s46, v1
    v_lshl_add_u32 v243, v1, 6, v243
    v_bfe_u32 v1, v255, 4, 1
    v_lshl_add_u32 v243, v1, 5, v243
    v_and_b32 v1, 3, v255
    v_lshl_add_u32 v243, v1, 3, v243
    v_add_u32 v243, s58, v243
    v_xor_b32 v244, 64, v243
    v_lshlrev_b32 v245, 4, v255
    v_and_b32 v246, 31, v255
    v_lshlrev_b32 v246, 2, v246
    s_lshl_b32 s46, s40, 2
    s_lshl_b32 s47, s56, 1
    s_add_u32 s46, s46, s47
    s_and_b32 s47, s43, 1
    s_add_u32 s48, s46, s47
    s_xor_b32 s49, s48, 1
    s_mul_i32 s61, s48, 112
    s_mul_i32 s62, s49, 112
    s_mul_i32 s47, s43, 28
    s_add_u32 s61, s61, s47
    s_add_u32 s62, s62, s47
    s_lshl_b32 s61, s61, 10
    s_lshl_b32 s62, s62, 10
    s_add_u32 s61, s61, 1048576
    s_add_u32 s62, s62, 1048576
    s_lshl_b32 s85, s40, 1
    s_add_u32 s85, s85, s57
    s_mul_i32 s47, s85, 37
    s_lshr_b32 s47, s47, 8
    s_mul_i32 s47, s47, 7
    s_sub_u32 s85, s85, s47
    s_mul_i32 s85, s85, 1
    s_mov_b32 s86, s85
    s_lshl_b32 s47, s85, 12
    s_add_u32 s61, s61, s47
    s_add_u32 s62, s62, s47
    s_mul_i32 s47, s85, 57344
    s_add_u32 s59, s59, s47
    s_lshl_b32 s88, s48, 5
    s_lshl_b32 s47, s43, 3
    s_add_u32 s88, s88, s47
    s_and_b32 s87, s57, 1
    s_lshl_b32 s47, s87, 3
    s_xor_b32 s88, s88, s47
    s_xor_b32 s89, s88, 8
    s_lshl_b32 s88, s88, 10
    s_lshl_b32 s89, s89, 10
    s_add_u32 s88, s88, 8388608
    s_add_u32 s89, s89, 8388608
    s_add_u32 s80, s88, 4096
    s_add_u32 s81, s89, 4096
    s_lshl_b32 s63, s40, 13
    s_add_u32 s63, s63, 10485760
    s_lshr_b32 s47, s43, 1
    s_lshl_b32 s47, s47, 9
    s_add_u32 s3, s63, s47
    s_lshl_b32 s47, s56, 9
    s_add_u32 s63, s63, s47
    s_lshl_b32 s47, s43, 7
    s_add_u32 s63, s63, s47
    s_mul_i32 s47, s43, 7
    s_and_b32 s47, s47, 0xfe
    s_mov_b64 s[90:91], 0xff
    s_lshl_b64 s[90:91], s[90:91], s47
    s_mov_b64 s[92:93], 0xff
    s_lshl_b32 s47, s100, 3
    s_mul_i32 s49, s47, 37
    s_lshr_b32 s49, s49, 10
    s_add_u32 s47, s47, 7
    s_mul_i32 s47, s47, 37
    s_lshr_b32 s47, s47, 10
    s_min_u32 s47, s47, 3
    v_mov_b32 v1, s49
    v_mov_b32 v2, s47
    v_cmp_eq_u32 vcc, 0, v255
    s_lshl_b32 s47, s100, 3
    s_and_b32 s49, s43, 1
    s_lshl_b32 s49, s49, 2
    s_add_u32 s47, s47, s49
    v_cndmask_b32 v1, v2, v1, vcc
    v_lshl_add_u32 v250, v1, 7, s47
    v_mov_b32 v252, 1
    v_and_b32 v1, 31, v255
    v_mul_u32_u24 v247, 896, v1
    v_lshrrev_b32 v1, 5, v255
    v_lshl_add_u32 v248, v1, 4, v247
    v_lshl_add_u32 v247, v1, 3, v247
    s_mul_i32 s94, s48, 28672
    s_lshl_b32 s47, s57, 7
    s_add_u32 s94, s94, s47
    s_lshr_b32 s47, s43, 1
    s_lshl_b32 s47, s47, 6
    s_add_u32 s94, s94, s47
    s_lshl_b32 s7, s40, 13
    s_add_u32 s7, s7, 10486784
    s_and_b32 s47, s48, 3
    s_mul_i32 s47, s47, 1792
    s_add_u32 s7, s7, s47
    s_lshr_b32 s47, s43, 1
    s_mul_i32 s47, s47, 896
    s_add_u32 s7, s7, s47
    s_lshl_b32 s47, s57, 7
    s_add_u32 s7, s7, s47
    v_mov_b32 v16, 0
    v_mov_b32 v17, 0
    v_mov_b32 v18, 0
    v_mov_b32 v19, 0
    v_mov_b32 v20, 0
    v_mov_b32 v21, 0
    v_mov_b32 v22, 0
    v_mov_b32 v23, 0
    v_mov_b32 v24, 0
    v_mov_b32 v25, 0
    v_mov_b32 v26, 0
    v_mov_b32 v27, 0
    v_mov_b32 v28, 0
    v_mov_b32 v29, 0
    v_mov_b32 v30, 0
    v_mov_b32 v31, 0
    v_mov_b32 v32, 0
    v_mov_b32 v33, 0
    v_mov_b32 v34, 0
    v_mov_b32 v35, 0
    v_mov_b32 v36, 0
    v_mov_b32 v37, 0
    v_mov_b32 v38, 0
    v_mov_b32 v39, 0
    v_mov_b32 v40, 0
    v_mov_b32 v41, 0
    v_mov_b32 v42, 0
    v_mov_b32 v43, 0
    v_mov_b32 v44, 0
    v_mov_b32 v45, 0
    v_mov_b32 v46, 0
    v_mov_b32 v47, 0
    v_mov_b32 v48, 0
    v_mov_b32 v49, 0
    v_mov_b32 v50, 0
    v_mov_b32 v51, 0
    v_mov_b32 v52, 0
    v_mov_b32 v53, 0
    v_mov_b32 v54, 0
    v_mov_b32 v55, 0
    v_mov_b32 v56, 0
    v_mov_b32 v57, 0
    v_mov_b32 v58, 0
    v_mov_b32 v59, 0
    v_mov_b32 v60, 0
    v_mov_b32 v61, 0
    v_mov_b32 v62, 0
    v_mov_b32 v63, 0
    s_barrier
    s_add_u32 m0, s53, 49152
    s_nop 0
    buffer_load_dwordx4 v241, s[12:15], s52 offen lds
    s_add_u32 s97, s97, 1
    s_add_u32 s52, s52, 57344
    s_cmp_eq_u32 s97, 7
    s_cselect_b32 s97, 0, s97
    s_cselect_b32 s46, 401408, 0
    s_sub_u32 s52, s52, s46
    s_add_u32 m0, s51, 53248
    s_add_u32 s46, s50, 0
    buffer_load_dwordx4 v240, s[16:19], s46 offen lds
    s_add_u32 m0, s51, 57344
    s_add_u32 s46, s50, 57344
    buffer_load_dwordx4 v240, s[16:19], s46 offen lds
    s_add_u32 m0, s51, 61440
    s_add_u32 s46, s50, 114688
    buffer_load_dwordx4 v240, s[16:19], s46 offen lds
    s_add_u32 m0, s51, 65536
    s_add_u32 s46, s50, 172032
    buffer_load_dwordx4 v240, s[16:19], s46 offen lds
    s_add_u32 s96, s96, 1
    s_add_u32 s50, s50, 229376
    s_cmp_eq_u32 s96, 7
    s_cselect_b32 s96, 0, s96
    s_cselect_b32 s46, 1605632, 0
    s_sub_u32 s50, s50, s46
    s_add_u32 m0, s53, 69632
    s_nop 0
    buffer_load_dwordx4 v241, s[12:15], s52 offen lds
    s_add_u32 s97, s97, 1
    s_add_u32 s52, s52, 57344
    s_cmp_eq_u32 s97, 7
    s_cselect_b32 s97, 0, s97
    s_cselect_b32 s46, 401408, 0
    s_sub_u32 s52, s52, s46
    s_add_u32 m0, s51, 73728
    s_add_u32 s46, s50, 0
    buffer_load_dwordx4 v240, s[16:19], s46 offen lds
    s_add_u32 m0, s51, 77824
    s_add_u32 s46, s50, 57344
    buffer_load_dwordx4 v240, s[16:19], s46 offen lds
    s_add_u32 m0, s51, 81920
    s_add_u32 s46, s50, 114688
    buffer_load_dwordx4 v240, s[16:19], s46 offen lds
    s_add_u32 m0, s51, 86016
    s_add_u32 s46, s50, 172032
    buffer_load_dwordx4 v240, s[16:19], s46 offen lds
    s_add_u32 s96, s96, 1
    s_add_u32 s50, s50, 229376
    s_cmp_eq_u32 s96, 7
    s_cselect_b32 s96, 0, s96
    s_cselect_b32 s46, 1605632, 0
    s_sub_u32 s50, s50, s46
    s_add_u32 m0, s53, 90112
    s_nop 0
    buffer_load_dwordx4 v241, s[12:15], s52 offen lds
    s_add_u32 s97, s97, 1
    s_add_u32 s52, s52, 57344
    s_cmp_eq_u32 s97, 7
    s_cselect_b32 s97, 0, s97
    s_cselect_b32 s46, 401408, 0
    s_sub_u32 s52, s52, s46
    s_add_u32 m0, s51, 94208
    s_add_u32 s46, s50, 0
    buffer_load_dwordx4 v240, s[16:19], s46 offen lds
    s_waitcnt vmcnt(7)
    s_barrier
    s_add_u32 m0, s51, 0
    s_add_u32 s46, s50, 57344
    buffer_load_dwordx4 v240, s[16:19], s46 offen lds
    s_add_u32 m0, s51, 4096
    s_add_u32 s46, s50, 114688
    buffer_load_dwordx4 v240, s[16:19], s46 offen lds
    s_add_u32 m0, s51, 8192
    s_add_u32 s46, s50, 172032
    buffer_load_dwordx4 v240, s[16:19], s46 offen lds
    s_add_u32 s96, s96, 1
    s_add_u32 s50, s50, 229376
    s_cmp_eq_u32 s96, 7
    s_cselect_b32 s96, 0, s96
    s_cselect_b32 s46, 1605632, 0
    s_sub_u32 s50, s50, s46
    s_add_u32 m0, s53, 12288
    s_nop 0
    buffer_load_dwordx4 v241, s[12:15], s52 offen lds
    s_add_u32 s97, s97, 1
    s_add_u32 s52, s52, 57344
    s_cmp_eq_u32 s97, 7
    s_cselect_b32 s97, 0, s97
    s_cselect_b32 s46, 401408, 0
    s_sub_u32 s52, s52, s46
    s_add_u32 m0, s51, 16384
    s_add_u32 s46, s50, 0
    buffer_load_dwordx4 v240, s[16:19], s46 offen lds
    s_add_u32 m0, s51, 20480
    s_add_u32 s46, s50, 57344
    buffer_load_dwordx4 v240, s[16:19], s46 offen lds
    s_waitcnt vmcnt(9)
    s_barrier
    s_add_u32 m0, s51, 24576
    s_add_u32 s46, s50, 114688
    buffer_load_dwordx4 v240, s[16:19], s46 offen lds
    s_add_u32 m0, s51, 28672
    s_add_u32 s46, s50, 172032
    buffer_load_dwordx4 v240, s[16:19], s46 offen lds
    s_add_u32 s96, s96, 1
    s_add_u32 s50, s50, 229376
    s_cmp_eq_u32 s96, 7
    s_cselect_b32 s96, 0, s96
    s_cselect_b32 s46, 1605632, 0
    s_sub_u32 s50, s50, s46
    s_add_u32 m0, s51, 32768
    s_add_u32 s46, s50, 0
    buffer_load_dwordx4 v240, s[16:19], s46 offen lds
    s_add_u32 m0, s51, 36864
    s_add_u32 s46, s50, 57344
    buffer_load_dwordx4 v240, s[16:19], s46 offen lds
    s_add_u32 m0, s51, 40960
    s_add_u32 s46, s50, 114688
    buffer_load_dwordx4 v240, s[16:19], s46 offen lds
    s_add_u32 m0, s51, 45056
    s_add_u32 s46, s50, 172032
    buffer_load_dwordx4 v240, s[16:19], s46 offen lds
    s_add_u32 s96, s96, 1
    s_add_u32 s50, s50, 229376
    s_cmp_eq_u32 s96, 7
    s_cselect_b32 s96, 0, s96
    s_cselect_b32 s46, 1605632, 0
    s_sub_u32 s50, s50, s46
    s_add_u32 m0, s58, 0
    s_add_u32 s46, s59, 0
    buffer_load_dwordx4 v242, s[24:27], s46 offen lds
    s_add_u32 m0, s58, 1024
    s_add_u32 s46, s59, 7168
    buffer_load_dwordx4 v242, s[24:27], s46 offen lds
    s_waitcnt vmcnt(13)
    s_barrier
    s_add_u32 m0, s51, 49152
    s_add_u32 s46, s50, 0
    buffer_load_dwordx4 v240, s[16:19], s46 offen lds
    s_add_u32 m0, s51, 53248
    s_add_u32 s46, s50, 57344
    buffer_load_dwordx4 v240, s[16:19], s46 offen lds
    s_add_u32 m0, s51, 57344
    s_add_u32 s46, s50, 114688
    buffer_load_dwordx4 v240, s[16:19], s46 offen lds
    s_add_u32 m0, s51, 61440
    s_add_u32 s46, s50, 172032
    buffer_load_dwordx4 v240, s[16:19], s46 offen lds
    s_add_u32 s96, s96, 1
    s_add_u32 s50, s50, 229376
    s_cmp_eq_u32 s96, 7
    s_cselect_b32 s96, 0, s96
    s_cselect_b32 s46, 1605632, 0
    s_sub_u32 s50, s50, s46
    s_add_u32 m0, s51, 65536
    s_add_u32 s46, s50, 0
    buffer_load_dwordx4 v240, s[16:19], s46 offen lds
    s_add_u32 m0, s51, 73728
    s_add_u32 s46, s50, 57344
    buffer_load_dwordx4 v240, s[16:19], s46 offen lds
    s_waitcnt vmcnt(15)
    s_barrier
    s_add_u32 m0, s51, 77824
    s_add_u32 s46, s50, 114688
    buffer_load_dwordx4 v240, s[16:19], s46 offen lds
    s_add_u32 m0, s51, 81920
    s_add_u32 s46, s50, 172032
    buffer_load_dwordx4 v240, s[16:19], s46 offen lds
    s_add_u32 s96, s96, 1
    s_add_u32 s50, s50, 229376
    s_cmp_eq_u32 s96, 7
    s_cselect_b32 s96, 0, s96
    s_cselect_b32 s46, 1605632, 0
    s_sub_u32 s50, s50, s46
    s_add_u32 m0, s53, 86016
    s_nop 0
    buffer_load_dwordx4 v241, s[12:15], s52 offen lds
    s_add_u32 s97, s97, 1
    s_add_u32 s52, s52, 57344
    s_cmp_eq_u32 s97, 7
    s_cselect_b32 s97, 0, s97
    s_cselect_b32 s46, 401408, 0
    s_sub_u32 s52, s52, s46
    s_add_u32 m0, s53, 94208
    s_nop 0
    buffer_load_dwordx4 v241, s[12:15], s52 offen lds
    s_add_u32 s97, s97, 1
    s_add_u32 s52, s52, 57344
    s_cmp_eq_u32 s97, 7
    s_cselect_b32 s97, 0, s97
    s_cselect_b32 s46, 401408, 0
    s_sub_u32 s52, s52, s46
    s_add_u32 m0, s53, 69632
    s_nop 0
    buffer_load_dwordx4 v241, s[12:15], s52 offen lds
    s_add_u32 m0, s58, 8192
    s_add_u32 s46, s59, 14336
    buffer_load_dwordx4 v242, s[24:27], s46 offen lds
    s_add_u32 m0, s58, 9216
    s_add_u32 s46, s59, 21504
    buffer_load_dwordx4 v242, s[24:27], s46 offen lds
    s_waitcnt vmcnt(19)
    s_barrier
    s_add_u32 m0, s51, 90112
    s_add_u32 s46, s50, 128
    buffer_load_dwordx4 v240, s[16:19], s46 offen lds
    s_add_u32 m0, s51, 0
    s_add_u32 s46, s50, 57472
    buffer_load_dwordx4 v240, s[16:19], s46 offen lds
    s_add_u32 m0, s51, 4096
    s_add_u32 s46, s50, 114816
    buffer_load_dwordx4 v240, s[16:19], s46 offen lds
    s_add_u32 m0, s51, 8192
    s_add_u32 s46, s50, 172160
    buffer_load_dwordx4 v240, s[16:19], s46 offen lds
    s_add_u32 s96, s96, 1
    s_add_u32 s50, s50, 229376
    s_cmp_eq_u32 s96, 7
    s_cselect_b32 s96, 0, s96
    s_cselect_b32 s46, 1605632, 0
    s_sub_u32 s50, s50, s46
    s_waitcnt vmcnt(9)
    s_barrier
    s_add_u32 m0, s51, 12288
    s_add_u32 s46, s50, 128
    buffer_load_dwordx4 v240, s[16:19], s46 offen lds
    s_add_u32 m0, s51, 16384
    s_add_u32 s46, s50, 57472
    buffer_load_dwordx4 v240, s[16:19], s46 offen lds
    s_add_u32 m0, s51, 20480
    s_add_u32 s46, s50, 114816
    buffer_load_dwordx4 v240, s[16:19], s46 offen lds
    s_add_u32 m0, s51, 24576
    s_add_u32 s46, s50, 172160
    buffer_load_dwordx4 v240, s[16:19], s46 offen lds
    s_add_u32 s96, s96, 1
    s_add_u32 s50, s50, 229376
    s_cmp_eq_u32 s96, 7
    s_cselect_b32 s96, 0, s96
    s_cselect_b32 s46, 1605632, 0
    s_sub_u32 s50, s50, s46
    s_add_u32 m0, s58, 16384
    s_add_u32 s46, s59, 28672
    buffer_load_dwordx4 v242, s[24:27], s46 offen lds
    s_add_u32 m0, s58, 17408
    s_add_u32 s46, s59, 35840
    buffer_load_dwordx4 v242, s[24:27], s46 offen lds
    s_barrier
    s_add_u32 m0, s51, 28672
    s_add_u32 s46, s50, 128
    buffer_load_dwordx4 v240, s[16:19], s46 offen lds
    s_barrier
    s_add_u32 m0, s58, 24576
    s_add_u32 s46, s59, 43008
    buffer_load_dwordx4 v242, s[24:27], s46 offen lds
    s_add_u32 m0, s58, 25600
    s_add_u32 s46, s59, 50176
    buffer_load_dwordx4 v242, s[24:27], s46 offen lds
    s_add_u32 s85, s85, 1
    s_add_u32 s59, s59, 57344
    s_cmp_eq_u32 s85, 7
    s_cselect_b32 s85, 0, s85
    s_cselect_b32 s46, 401408, 0
    s_sub_u32 s59, s59, s46
    s_waitcnt vmcnt(15)
    s_barrier
    s_add_u32 m0, s51, 32768
    s_add_u32 s46, s50, 57472
    buffer_load_dwordx4 v240, s[16:19], s46 offen lds
    s_add_u32 m0, s51, 36864
    s_add_u32 s46, s50, 114816
    buffer_load_dwordx4 v240, s[16:19], s46 offen lds
    s_add_u32 m0, s51, 40960
    s_add_u32 s46, s50, 172160
    buffer_load_dwordx4 v240, s[16:19], s46 offen lds
    s_add_u32 s96, s96, 1
    s_add_u32 s50, s50, 229376
    s_cmp_eq_u32 s96, 7
    s_cselect_b32 s96, 0, s96
    s_cselect_b32 s46, 1605632, 0
    s_sub_u32 s50, s50, s46
    s_add_u32 m0, s51, 45056
    s_add_u32 s46, s50, 128
    buffer_load_dwordx4 v240, s[16:19], s46 offen lds
    s_add_u32 m0, s51, 49152
    s_add_u32 s46, s50, 57472
    buffer_load_dwordx4 v240, s[16:19], s46 offen lds
    s_waitcnt vmcnt(17)
    s_barrier
    s_add_u32 m0, s51, 53248
    s_add_u32 s46, s50, 114816
    buffer_load_dwordx4 v240, s[16:19], s46 offen lds
    s_add_u32 m0, s51, 57344
    s_add_u32 s46, s50, 172160
    buffer_load_dwordx4 v240, s[16:19], s46 offen lds
    s_add_u32 s96, s96, 1
    s_add_u32 s50, s50, 229376
    s_cmp_eq_u32 s96, 7
    s_cselect_b32 s96, 0, s96
    s_cselect_b32 s46, 1605632, 0
    s_sub_u32 s50, s50, s46
    s_add_u32 m0, s51, 61440
    s_add_u32 s46, s50, 128
    buffer_load_dwordx4 v240, s[16:19], s46 offen lds
    s_add_u32 m0, s51, 65536
    s_add_u32 s46, s50, 57472
    buffer_load_dwordx4 v240, s[16:19], s46 offen lds
    s_add_u32 m0, s51, 73728
    s_add_u32 s46, s50, 114816
    buffer_load_dwordx4 v240, s[16:19], s46 offen lds
    s_add_u32 m0, s51, 77824
    s_add_u32 s46, s50, 172160
    buffer_load_dwordx4 v240, s[16:19], s46 offen lds
    s_add_u32 s96, s96, 1
    s_add_u32 s50, s50, 229376
    s_cmp_eq_u32 s96, 7
    s_cselect_b32 s96, 0, s96
    s_cselect_b32 s46, 1605632, 0
    s_sub_u32 s50, s50, s46
    s_add_u32 m0, s58, 32768
    s_add_u32 s46, s59, 0
    buffer_load_dwordx4 v242, s[24:27], s46 offen lds
    s_add_u32 m0, s58, 33792
    s_add_u32 s46, s59, 7168
    buffer_load_dwordx4 v242, s[24:27], s46 offen lds
    s_waitcnt vmcnt(22)
    s_barrier
    s_add_u32 m0, s51, 81920
    s_add_u32 s46, s50, 128
    buffer_load_dwordx4 v240, s[16:19], s46 offen lds
    s_add_u32 m0, s51, 86016
    s_add_u32 s46, s50, 57472
    buffer_load_dwordx4 v240, s[16:19], s46 offen lds
    s_add_u32 m0, s51, 94208
    s_add_u32 s46, s50, 114816
    buffer_load_dwordx4 v240, s[16:19], s46 offen lds
    s_add_u32 m0, s51, 69632
    s_add_u32 s46, s50, 172160
    buffer_load_dwordx4 v240, s[16:19], s46 offen lds
    s_add_u32 s96, s96, 1
    s_add_u32 s50, s50, 229376
    s_cmp_eq_u32 s96, 7
    s_cselect_b32 s96, 0, s96
    s_cselect_b32 s46, 1605632, 0
    s_sub_u32 s50, s50, s46
    s_waitcnt vmcnt(23)
    s_barrier
    s_add_u32 m0, s51, 90112
    s_add_u32 s46, s50, 128
    buffer_load_dwordx4 v240, s[16:19], s46 offen lds
    s_add_u32 m0, s51, 0
    s_add_u32 s46, s50, 57472
    buffer_load_dwordx4 v240, s[16:19], s46 offen lds
    s_add_u32 m0, s51, 4096
    s_add_u32 s46, s50, 114816
    buffer_load_dwordx4 v240, s[16:19], s46 offen lds
    s_add_u32 m0, s58, 40960
    s_add_u32 s46, s59, 14336
    buffer_load_dwordx4 v242, s[24:27], s46 offen lds
    s_add_u32 m0, s58, 41984
    s_add_u32 s46, s59, 21504
    buffer_load_dwordx4 v242, s[24:27], s46 offen lds
    s_waitcnt vmcnt(21)
    s_barrier
    s_add_u32 m0, s51, 8192
    s_add_u32 s46, s50, 172160
    buffer_load_dwordx4 v240, s[16:19], s46 offen lds
    s_waitcnt vmcnt(19)
    s_barrier
    s_add_u32 m0, s58, 49152
    s_add_u32 s46, s59, 28672
    buffer_load_dwordx4 v242, s[24:27], s46 offen lds
    s_add_u32 m0, s58, 50176
    s_add_u32 s46, s59, 35840
    buffer_load_dwordx4 v242, s[24:27], s46 offen lds
    s_waitcnt vmcnt(7)
    s_barrier
    v_mov_b32 v1, 0
    s_cmp_lg_u32 s43, 0
    s_cbranch_scc1 L_nokv0
    s_mov_b64 exec, 1
    buffer_load_dword v2, v1, s[36:39], 0 offen sc1
    s_mov_b64 exec, -1
L_nokv0:
    s_cmp_lg_u32 s43, 0
    s_cbranch_scc1 L_nokvp
    s_waitcnt vmcnt(0)
    v_readfirstlane_b32 s44, v2
    s_cmp_ge_u32 s44, 32
    s_cbranch_scc1 L_nokvp
    s_mov_b64 s[54:55], 1
    s_mov_b64 exec, 1
    s_mov_b32 s46, 200000
L_poll_1:
    buffer_load_dword v2, v1, s[36:39], 0 offen sc1
    s_waitcnt vmcnt(0)
    v_cmp_le_u32 vcc, 32, v2
    s_nop 1
    s_and_b64 s[44:45], vcc, s[54:55]
    s_cmp_eq_u64 s[44:45], s[54:55]
    s_cbranch_scc1 L_polld_2
    s_sleep 2
    s_sub_u32 s46, s46, 1
    s_cmp_lg_u32 s46, 0
    s_cbranch_scc1 L_poll_1
L_polld_2:
    s_mov_b64 exec, -1
L_nokvp:
    s_waitcnt vmcnt(2)
    s_barrier
    s_setprio 3
    buffer_load_dwordx2 v[64:65], v247, s[8:11], s94 offen offset:0
    buffer_load_dwordx2 v[66:67], v247, s[8:11], s94 offen offset:16
    buffer_load_dwordx2 v[68:69], v247, s[8:11], s94 offen offset:32
    buffer_load_dwordx2 v[70:71], v247, s[8:11], s94 offen offset:48
    s_waitcnt vmcnt(0)
    v_lshlrev_b32 v0, 16, v64
    v_and_b32 v1, 0xffff0000, v64
    v_lshlrev_b32 v2, 16, v65
    v_and_b32 v3, 0xffff0000, v65
    v_lshlrev_b32 v4, 16, v66
    v_and_b32 v5, 0xffff0000, v66
    v_lshlrev_b32 v6, 16, v67
    v_and_b32 v7, 0xffff0000, v67
    v_lshlrev_b32 v8, 16, v68
    v_and_b32 v9, 0xffff0000, v68
    v_lshlrev_b32 v10, 16, v69
    v_and_b32 v11, 0xffff0000, v69
    v_lshlrev_b32 v12, 16, v70
    v_and_b32 v13, 0xffff0000, v70
    v_lshlrev_b32 v14, 16, v71
    v_and_b32 v15, 0xffff0000, v71
    v_add_u32 v240, 65536, v243
    v_add_u32 v253, 147456, v243
    v_xor_b32 v241, 64, v240
    v_xor_b32 v254, 64, v253
    s_barrier
    s_mov_b64 exec, 3
    buffer_store_dword v252, v250, s[20:23], s3 offen sc1
    s_mov_b64 exec, -1
    s_add_u32 m0, s58, 65536
    s_add_u32 s46, s59, 43008
    buffer_load_dwordx4 v242, s[24:27], s46 offen lds
    s_add_u32 m0, s58, 66560
    s_add_u32 s46, s59, 50176
    buffer_load_dwordx4 v242, s[24:27], s46 offen lds
    s_add_u32 s85, s85, 1
    s_add_u32 s59, s59, 57344
    s_cmp_eq_u32 s85, 7
    s_cselect_b32 s85, 0, s85
    s_cselect_b32 s46, 401408, 0
    s_sub_u32 s59, s59, s46
    s_add_u32 m0, s58, 73728
    s_add_u32 s46, s59, 0
    buffer_load_dwordx4 v242, s[24:27], s46 offen lds
    s_waitcnt vmcnt(3)
    s_add_u32 m0, s58, 74752
    s_add_u32 s46, s59, 7168
    buffer_load_dwordx4 v242, s[24:27], s46 offen lds
    s_waitcnt vmcnt(3)
    s_add_u32 m0, s58, 81920
    s_add_u32 s46, s59, 14336
    buffer_load_dwordx4 v242, s[24:27], s46 offen lds
    s_waitcnt vmcnt(3)
    s_add_u32 m0, s58, 82944
    s_add_u32 s46, s59, 21504
    buffer_load_dwordx4 v242, s[24:27], s46 offen lds
    s_waitcnt vmcnt(3)
    s_add_u32 m0, s58, 90112
    s_add_u32 s46, s59, 28672
    buffer_load_dwordx4 v242, s[24:27], s46 offen lds
    s_waitcnt vmcnt(3)
    s_add_u32 m0, s58, 91136
    s_add_u32 s46, s59, 35840
    buffer_load_dwordx4 v242, s[24:27], s46 offen lds
    s_waitcnt vmcnt(3)
    s_add_u32 m0, s58, 147456
    s_add_u32 s46, s59, 43008
    buffer_load_dwordx4 v242, s[24:27], s46 offen lds
    s_waitcnt vmcnt(3)
    s_add_u32 m0, s58, 148480
    s_add_u32 s46, s59, 50176
    buffer_load_dwordx4 v242, s[24:27], s46 offen lds
    s_add_u32 s85, s85, 1
    s_add_u32 s59, s59, 57344
    s_cmp_eq_u32 s85, 7
    s_cselect_b32 s85, 0, s85
    s_cselect_b32 s46, 401408, 0
    s_sub_u32 s59, s59, s46
    s_waitcnt vmcnt(3)
    s_add_u32 m0, s58, 155648
    s_add_u32 s46, s59, 0
    buffer_load_dwordx4 v242, s[24:27], s46 offen lds
    s_waitcnt vmcnt(3)
    s_add_u32 m0, s58, 156672
    s_add_u32 s46, s59, 7168
    buffer_load_dwordx4 v242, s[24:27], s46 offen lds
    s_waitcnt vmcnt(3)
    s_add_u32 m0, s58, 57344
    s_add_u32 s46, s59, 14336
    buffer_load_dwordx4 v242, s[24:27], s46 offen lds
    s_waitcnt vmcnt(3)
    s_add_u32 m0, s58, 58368
    s_add_u32 s46, s59, 21504
    buffer_load_dwordx4 v242, s[24:27], s46 offen lds
    s_waitcnt vmcnt(3)
    s_mov_b32 s46, 200000
L_poll_3:
    buffer_load_dword v249, v246, s[20:23], s63 offen sc1
    s_waitcnt vmcnt(0)
    v_cmp_le_u32 vcc, 1, v249
    s_nop 1
    s_and_b64 s[44:45], vcc, s[90:91]
    s_cmp_eq_u64 s[44:45], s[90:91]
    s_cbranch_scc1 L_polld_4
    s_sleep 2
    s_sub_u32 s46, s46, 1
    s_cmp_lg_u32 s46, 0
    s_cbranch_scc1 L_poll_3
L_polld_4:
    buffer_load_dwordx4 v[80:83], v245, s[20:23], s61 offen offset:0 sc1
    buffer_load_dwordx4 v[84:87], v245, s[20:23], s62 offen offset:0 sc1
    buffer_load_dwordx4 v[88:91], v245, s[20:23], s61 offen offset:1024 sc1
    buffer_load_dwordx4 v[92:95], v245, s[20:23], s62 offen offset:1024 sc1
    s_waitcnt vmcnt(3)
    buffer_load_dwordx4 v[96:99], v245, s[20:23], s61 offen offset:2048 sc1
    s_waitcnt vmcnt(3)
    buffer_load_dwordx4 v[100:103], v245, s[20:23], s62 offen offset:2048 sc1
    s_waitcnt vmcnt(3)
    buffer_load_dwordx4 v[104:107], v245, s[20:23], s61 offen offset:3072 sc1
    s_waitcnt vmcnt(3)
    buffer_load_dwordx4 v[108:111], v245, s[20:23], s62 offen offset:3072 sc1
    s_sub_u32 s62, s62, s61
    s_add_u32 s86, s86, 1
    s_add_u32 s61, s61, 4096
    s_cmp_eq_u32 s86, 7
    s_cselect_b32 s86, 0, s86
    s_cselect_b32 s46, 28672, 0
    s_sub_u32 s61, s61, s46
    s_add_u32 s62, s62, s61
    s_waitcnt vmcnt(3)
    buffer_load_dwordx4 v[112:115], v245, s[20:23], s61 offen offset:0 sc1
    s_waitcnt vmcnt(3)
    buffer_load_dwordx4 v[116:119], v245, s[20:23], s62 offen offset:0 sc1
    s_waitcnt vmcnt(3)
    buffer_load_dwordx4 v[120:123], v245, s[20:23], s61 offen offset:1024 sc1
    s_waitcnt vmcnt(3)
    buffer_load_dwordx4 v[124:127], v245, s[20:23], s62 offen offset:1024 sc1
    s_waitcnt vmcnt(3)
    buffer_load_dwordx4 v[128:131], v245, s[20:23], s61 offen offset:2048 sc1
    s_waitcnt vmcnt(3)
    buffer_load_dwordx4 v[132:135], v245, s[20:23], s62 offen offset:2048 sc1
    s_waitcnt vmcnt(3)
    buffer_load_dwordx4 v[136:139], v245, s[20:23], s61 offen offset:3072 sc1
    s_waitcnt vmcnt(3)
    buffer_load_dwordx4 v[140:143], v245, s[20:23], s62 offen offset:3072 sc1
    s_sub_u32 s62, s62, s61
    s_add_u32 s86, s86, 1
    s_add_u32 s61, s61, 4096
    s_cmp_eq_u32 s86, 7
    s_cselect_b32 s86, 0, s86
    s_cselect_b32 s46, 28672, 0
    s_sub_u32 s61, s61, s46
    s_add_u32 s62, s62, s61
    s_waitcnt vmcnt(3)
    buffer_load_dwordx4 v[144:147], v245, s[20:23], s61 offen offset:0 sc1
    s_waitcnt vmcnt(3)
    buffer_load_dwordx4 v[148:151], v245, s[20:23], s62 offen offset:0 sc1
    s_waitcnt vmcnt(3)
    buffer_load_dwordx4 v[152:155], v245, s[20:23], s61 offen offset:1024 sc1
    s_waitcnt vmcnt(3)
    buffer_load_dwordx4 v[156:159], v245, s[20:23], s62 offen offset:1024 sc1
    s_waitcnt vmcnt(3)
    buffer_load_dwordx4 v[160:163], v245, s[20:23], s61 offen offset:2048 sc1
    s_waitcnt vmcnt(3)
    buffer_load_dwordx4 v[164:167], v245, s[20:23], s62 offen offset:2048 sc1
    s_waitcnt vmcnt(3)
    buffer_load_dwordx4 v[168:171], v245, s[20:23], s61 offen offset:3072 sc1
    s_waitcnt vmcnt(3)
    buffer_load_dwordx4 v[172:175], v245, s[20:23], s62 offen offset:3072 sc1
    s_sub_u32 s62, s62, s61
    s_add_u32 s86, s86, 1
    s_add_u32 s61, s61, 4096
    s_cmp_eq_u32 s86, 7
    s_cselect_b32 s86, 0, s86
    s_cselect_b32 s46, 28672, 0
    s_sub_u32 s61, s61, s46
    s_add_u32 s62, s62, s61
    s_waitcnt vmcnt(3)
    buffer_load_dwordx4 v[176:179], v245, s[20:23], s61 offen offset:0 sc1
    s_waitcnt vmcnt(3)
    buffer_load_dwordx4 v[180:183], v245, s[20:23], s62 offen offset:0 sc1
    s_waitcnt vmcnt(3)
    buffer_load_dwordx4 v[184:187], v245, s[20:23], s61 offen offset:1024 sc1
    s_waitcnt vmcnt(3)
    buffer_load_dwordx4 v[188:191], v245, s[20:23], s62 offen offset:1024 sc1
    s_waitcnt vmcnt(3)
    buffer_load_dwordx4 v[192:195], v245, s[20:23], s61 offen offset:2048 sc1
    s_waitcnt vmcnt(3)
    buffer_load_dwordx4 v[196:199], v245, s[20:23], s62 offen offset:2048 sc1
    s_waitcnt vmcnt(3)
    buffer_load_dwordx4 v[200:203], v245, s[20:23], s61 offen offset:3072 sc1
    s_waitcnt vmcnt(3)
    buffer_load_dwordx4 v[204:207], v245, s[20:23], s62 offen offset:3072 sc1
    s_sub_u32 s62, s62, s61
    s_add_u32 s86, s86, 1
    s_add_u32 s61, s61, 4096
    s_cmp_eq_u32 s86, 7
    s_cselect_b32 s86, 0, s86
    s_cselect_b32 s46, 28672, 0
    s_sub_u32 s61, s61, s46
    s_add_u32 s62, s62, s61
    s_waitcnt vmcnt(3)
    buffer_load_dwordx4 v[208:211], v245, s[20:23], s61 offen offset:0 sc1
    s_waitcnt vmcnt(3)
    buffer_load_dwordx4 v[212:215], v245, s[20:23], s62 offen offset:0 sc1
    s_waitcnt vmcnt(3)
    buffer_load_dwordx4 v[216:219], v245, s[20:23], s61 offen offset:1024 sc1
    s_waitcnt vmcnt(3)
    buffer_load_dwordx4 v[220:223], v245, s[20:23], s62 offen offset:1024 sc1
    s_waitcnt vmcnt(3)
    buffer_load_dwordx4 v[224:227], v245, s[20:23], s61 offen offset:2048 sc1
    s_waitcnt vmcnt(3)
    buffer_load_dwordx4 v[228:231], v245, s[20:23], s62 offen offset:2048 sc1
    s_waitcnt vmcnt(3)
    buffer_load_dwordx4 v[232:235], v245, s[20:23], s61 offen offset:3072 sc1
    s_waitcnt vmcnt(3)
    buffer_load_dwordx4 v[236:239], v245, s[20:23], s62 offen offset:3072 sc1
    s_sub_u32 s62, s62, s61
    s_add_u32 s86, s86, 1
    s_add_u32 s61, s61, 4096
    s_cmp_eq_u32 s86, 7
    s_cselect_b32 s86, 0, s86
    s_cselect_b32 s46, 28672, 0
    s_sub_u32 s61, s61, s46
    s_add_u32 s62, s62, s61
    s_waitcnt vmcnt(3)
    ds_read_b64_tr_b16 v[64:65], v243 offset:0
    ds_read_b64_tr_b16 v[66:67], v243 offset:1024
    ds_read_b64_tr_b16 v[68:69], v244 offset:0
    ds_read_b64_tr_b16 v[70:71], v244 offset:1024
    ds_read_b64_tr_b16 v[72:73], v243 offset:8192
    ds_read_b64_tr_b16 v[74:75], v243 offset:9216
    ds_read_b64_tr_b16 v[76:77], v244 offset:8192
    ds_read_b64_tr_b16 v[78:79], v244 offset:9216
    s_waitcnt lgkmcnt(4)
    v_mfma_f32_32x32x16_bf16 v[0:15], v[64:67], v[80:83], v[0:15]
    v_mfma_f32_32x32x16_bf16 v[16:31], v[68:71], v[80:83], v[16:31]
    v_mfma_f32_32x32x16_bf16 v[32:47], v[64:67], v[84:87], v[32:47]
    v_mfma_f32_32x32x16_bf16 v[48:63], v[68:71], v[84:87], v[48:63]
    s_add_u32 m0, s58, 0
    s_add_u32 s46, s59, 28672
    buffer_load_dwordx4 v242, s[24:27], s46 offen lds
    s_waitcnt vmcnt(3)
    s_add_u32 m0, s58, 1024
    s_add_u32 s46, s59, 35840
    buffer_load_dwordx4 v242, s[24:27], s46 offen lds
    s_waitcnt vmcnt(3)
    buffer_load_dwordx4 v[80:83], v245, s[20:23], s61 offen offset:0 sc1
    s_waitcnt vmcnt(3)
    buffer_load_dwordx4 v[84:87], v245, s[20:23], s62 offen offset:0 sc1
    s_waitcnt vmcnt(3)
    ds_read_b64_tr_b16 v[64:65], v243 offset:16384
    ds_read_b64_tr_b16 v[66:67], v243 offset:17408
    ds_read_b64_tr_b16 v[68:69], v244 offset:16384
    ds_read_b64_tr_b16 v[70:71], v244 offset:17408
    s_waitcnt lgkmcnt(4)
    v_mfma_f32_32x32x16_bf16 v[0:15], v[72:75], v[88:91], v[0:15]
    v_mfma_f32_32x32x16_bf16 v[16:31], v[76:79], v[88:91], v[16:31]
    v_mfma_f32_32x32x16_bf16 v[32:47], v[72:75], v[92:95], v[32:47]
    v_mfma_f32_32x32x16_bf16 v[48:63], v[76:79], v[92:95], v[48:63]
    s_add_u32 m0, s58, 8192
    s_add_u32 s46, s59, 43008
    buffer_load_dwordx4 v242, s[24:27], s46 offen lds
    s_waitcnt vmcnt(3)
    s_add_u32 m0, s58, 9216
    s_add_u32 s46, s59, 50176
    buffer_load_dwordx4 v242, s[24:27], s46 offen lds
    s_add_u32 s85, s85, 1
    s_add_u32 s59, s59, 57344
    s_cmp_eq_u32 s85, 7
    s_cselect_b32 s85, 0, s85
    s_cselect_b32 s46, 401408, 0
    s_sub_u32 s59, s59, s46
    s_waitcnt vmcnt(3)
    buffer_load_dwordx4 v[88:91], v245, s[20:23], s61 offen offset:1024 sc1
    s_waitcnt vmcnt(3)
    buffer_load_dwordx4 v[92:95], v245, s[20:23], s62 offen offset:1024 sc1
    s_waitcnt vmcnt(3)
    ds_read_b64_tr_b16 v[72:73], v243 offset:24576
    ds_read_b64_tr_b16 v[74:75], v243 offset:25600
    ds_read_b64_tr_b16 v[76:77], v244 offset:24576
    ds_read_b64_tr_b16 v[78:79], v244 offset:25600
    s_waitcnt lgkmcnt(4)
    v_mfma_f32_32x32x16_bf16 v[0:15], v[64:67], v[96:99], v[0:15]
    v_mfma_f32_32x32x16_bf16 v[16:31], v[68:71], v[96:99], v[16:31]
    v_mfma_f32_32x32x16_bf16 v[32:47], v[64:67], v[100:103], v[32:47]
    v_mfma_f32_32x32x16_bf16 v[48:63], v[68:71], v[100:103], v[48:63]
    s_add_u32 m0, s58, 16384
    s_add_u32 s46, s59, 0
    buffer_load_dwordx4 v242, s[24:27], s46 offen lds
    s_waitcnt vmcnt(3)
    s_add_u32 m0, s58, 17408
    s_add_u32 s46, s59, 7168
    buffer_load_dwordx4 v242, s[24:27], s46 offen lds
    s_waitcnt vmcnt(3)
    buffer_load_dwordx4 v[96:99], v245, s[20:23], s61 offen offset:2048 sc1
    s_waitcnt vmcnt(3)
    buffer_load_dwordx4 v[100:103], v245, s[20:23], s62 offen offset:2048 sc1
    s_waitcnt vmcnt(3)
    ds_read_b64_tr_b16 v[64:65], v243 offset:32768
    ds_read_b64_tr_b16 v[66:67], v243 offset:33792
    ds_read_b64_tr_b16 v[68:69], v244 offset:32768
    ds_read_b64_tr_b16 v[70:71], v244 offset:33792
    s_waitcnt lgkmcnt(4)
    v_mfma_f32_32x32x16_bf16 v[0:15], v[72:75], v[104:107], v[0:15]
    v_mfma_f32_32x32x16_bf16 v[16:31], v[76:79], v[104:107], v[16:31]
    v_mfma_f32_32x32x16_bf16 v[32:47], v[72:75], v[108:111], v[32:47]
    v_mfma_f32_32x32x16_bf16 v[48:63], v[76:79], v[108:111], v[48:63]
    s_add_u32 m0, s58, 24576
    s_add_u32 s46, s59, 14336
    buffer_load_dwordx4 v242, s[24:27], s46 offen lds
    s_waitcnt vmcnt(3)
    s_add_u32 m0, s58, 25600
    s_add_u32 s46, s59, 21504
    buffer_load_dwordx4 v242, s[24:27], s46 offen lds
    s_waitcnt vmcnt(3)
    buffer_load_dwordx4 v[104:107], v245, s[20:23], s61 offen offset:3072 sc1
    s_waitcnt vmcnt(3)
    buffer_load_dwordx4 v[108:111], v245, s[20:23], s62 offen offset:3072 sc1
    s_sub_u32 s62, s62, s61
    s_add_u32 s86, s86, 1
    s_add_u32 s61, s61, 4096
    s_cmp_eq_u32 s86, 7
    s_cselect_b32 s86, 0, s86
    s_cselect_b32 s46, 28672, 0
    s_sub_u32 s61, s61, s46
    s_add_u32 s62, s62, s61
    s_waitcnt vmcnt(3)
    ds_read_b64_tr_b16 v[72:73], v243 offset:40960
    ds_read_b64_tr_b16 v[74:75], v243 offset:41984
    ds_read_b64_tr_b16 v[76:77], v244 offset:40960
    ds_read_b64_tr_b16 v[78:79], v244 offset:41984
    s_waitcnt lgkmcnt(4)
    v_mfma_f32_32x32x16_bf16 v[0:15], v[64:67], v[112:115], v[0:15]
    v_mfma_f32_32x32x16_bf16 v[16:31], v[68:71], v[112:115], v[16:31]
    v_mfma_f32_32x32x16_bf16 v[32:47], v[64:67], v[116:119], v[32:47]
    v_mfma_f32_32x32x16_bf16 v[48:63], v[68:71], v[116:119], v[48:63]
    s_add_u32 m0, s58, 32768
    s_add_u32 s46, s59, 28672
    buffer_load_dwordx4 v242, s[24:27], s46 offen lds
    s_waitcnt vmcnt(3)
    s_add_u32 m0, s58, 33792
    s_add_u32 s46, s59, 35840
    buffer_load_dwordx4 v242, s[24:27], s46 offen lds
    s_waitcnt vmcnt(3)
    buffer_load_dwordx4 v[112:115], v245, s[20:23], s61 offen offset:0 sc1
    s_waitcnt vmcnt(3)
    buffer_load_dwordx4 v[116:119], v245, s[20:23], s62 offen offset:0 sc1
    s_waitcnt vmcnt(3)
    ds_read_b64_tr_b16 v[64:65], v243 offset:49152
    ds_read_b64_tr_b16 v[66:67], v243 offset:50176
    ds_read_b64_tr_b16 v[68:69], v244 offset:49152
    ds_read_b64_tr_b16 v[70:71], v244 offset:50176
    s_waitcnt lgkmcnt(4)
    v_mfma_f32_32x32x16_bf16 v[0:15], v[72:75], v[120:123], v[0:15]
    v_mfma_f32_32x32x16_bf16 v[16:31], v[76:79], v[120:123], v[16:31]
    v_mfma_f32_32x32x16_bf16 v[32:47], v[72:75], v[124:127], v[32:47]
    v_mfma_f32_32x32x16_bf16 v[48:63], v[76:79], v[124:127], v[48:63]
    s_add_u32 m0, s58, 40960
    s_add_u32 s46, s59, 43008
    buffer_load_dwordx4 v242, s[24:27], s46 offen lds
    s_waitcnt vmcnt(3)
    s_add_u32 m0, s58, 41984
    s_add_u32 s46, s59, 50176
    buffer_load_dwordx4 v242, s[24:27], s46 offen lds
    s_add_u32 s85, s85, 1
    s_add_u32 s59, s59, 57344
    s_cmp_eq_u32 s85, 7
    s_cselect_b32 s85, 0, s85
    s_cselect_b32 s46, 401408, 0
    s_sub_u32 s59, s59, s46
    s_waitcnt vmcnt(3)
    buffer_load_dwordx4 v[120:123], v245, s[20:23], s61 offen offset:1024 sc1
    s_waitcnt vmcnt(3)
    buffer_load_dwordx4 v[124:127], v245, s[20:23], s62 offen offset:1024 sc1
    s_waitcnt vmcnt(3)
    ds_read_b64_tr_b16 v[72:73], v240 offset:0
    ds_read_b64_tr_b16 v[74:75], v240 offset:1024
    ds_read_b64_tr_b16 v[76:77], v241 offset:0
    ds_read_b64_tr_b16 v[78:79], v241 offset:1024
    s_waitcnt lgkmcnt(4)
    v_mfma_f32_32x32x16_bf16 v[0:15], v[64:67], v[128:131], v[0:15]
    v_mfma_f32_32x32x16_bf16 v[16:31], v[68:71], v[128:131], v[16:31]
    v_mfma_f32_32x32x16_bf16 v[32:47], v[64:67], v[132:135], v[32:47]
    v_mfma_f32_32x32x16_bf16 v[48:63], v[68:71], v[132:135], v[48:63]
    s_add_u32 m0, s58, 49152
    s_add_u32 s46, s59, 0
    buffer_load_dwordx4 v242, s[24:27], s46 offen lds
    s_waitcnt vmcnt(3)
    s_add_u32 m0, s58, 50176
    s_add_u32 s46, s59, 7168
    buffer_load_dwordx4 v242, s[24:27], s46 offen lds
    s_waitcnt vmcnt(3)
    buffer_load_dwordx4 v[128:131], v245, s[20:23], s61 offen offset:2048 sc1
    s_waitcnt vmcnt(3)
    buffer_load_dwordx4 v[132:135], v245, s[20:23], s62 offen offset:2048 sc1
    s_waitcnt vmcnt(3)
    s_waitcnt lgkmcnt(0)
    v_mfma_f32_32x32x16_bf16 v[0:15], v[72:75], v[136:139], v[0:15]
    v_mfma_f32_32x32x16_bf16 v[16:31], v[76:79], v[136:139], v[16:31]
    v_mfma_f32_32x32x16_bf16 v[32:47], v[72:75], v[140:143], v[32:47]
    v_mfma_f32_32x32x16_bf16 v[48:63], v[76:79], v[140:143], v[48:63]
    s_add_u32 m0, s58, 65536
    s_add_u32 s46, s59, 14336
    buffer_load_dwordx4 v242, s[24:27], s46 offen lds
    s_waitcnt vmcnt(3)
    s_add_u32 m0, s58, 66560
    s_add_u32 s46, s59, 21504
    buffer_load_dwordx4 v242, s[24:27], s46 offen lds
    s_waitcnt vmcnt(3)
    buffer_load_dwordx4 v[136:139], v245, s[20:23], s61 offen offset:3072 sc1
    s_waitcnt vmcnt(3)
    buffer_load_dwordx4 v[140:143], v245, s[20:23], s62 offen offset:3072 sc1
    s_waitcnt vmcnt(3)
    ds_read_b64_tr_b16 v[64:65], v240 offset:8192
    ds_read_b64_tr_b16 v[66:67], v240 offset:9216
    ds_read_b64_tr_b16 v[68:69], v241 offset:8192
    ds_read_b64_tr_b16 v[70:71], v241 offset:9216
    s_setprio 1
    s_barrier
    ds_read_b64_tr_b16 v[72:73], v240 offset:16384
    ds_read_b64_tr_b16 v[74:75], v240 offset:17408
    ds_read_b64_tr_b16 v[76:77], v241 offset:16384
    ds_read_b64_tr_b16 v[78:79], v241 offset:17408
    s_waitcnt lgkmcnt(4)
    v_mfma_f32_32x32x16_bf16 v[0:15], v[64:67], v[144:147], v[0:15]
    s_add_u32 m0, s58, 73728
    s_add_u32 s46, s59, 28672
    buffer_load_dwordx4 v242, s[24:27], s46 offen lds
    s_add_u32 m0, s58, 74752
    s_add_u32 s46, s59, 35840
    buffer_load_dwordx4 v242, s[24:27], s46 offen lds
    v_mfma_f32_32x32x16_bf16 v[16:31], v[68:71], v[144:147], v[16:31]
    v_mfma_f32_32x32x16_bf16 v[32:47], v[64:67], v[148:151], v[32:47]
    v_mfma_f32_32x32x16_bf16 v[48:63], v[68:71], v[148:151], v[48:63]
    ds_read_b64_tr_b16 v[64:65], v240 offset:24576
    ds_read_b64_tr_b16 v[66:67], v240 offset:25600
    ds_read_b64_tr_b16 v[68:69], v241 offset:24576
    ds_read_b64_tr_b16 v[70:71], v241 offset:25600
    s_waitcnt lgkmcnt(4)
    v_mfma_f32_32x32x16_bf16 v[0:15], v[72:75], v[152:155], v[0:15]
    s_add_u32 m0, s58, 81920
    s_add_u32 s46, s59, 43008
    buffer_load_dwordx4 v242, s[24:27], s46 offen lds
    s_add_u32 m0, s58, 82944
    s_add_u32 s46, s59, 50176
    buffer_load_dwordx4 v242, s[24:27], s46 offen lds
    s_add_u32 s85, s85, 1
    s_add_u32 s59, s59, 57344
    s_cmp_eq_u32 s85, 7
    s_cselect_b32 s85, 0, s85
    s_cselect_b32 s46, 401408, 0
    s_sub_u32 s59, s59, s46
    v_mfma_f32_32x32x16_bf16 v[16:31], v[76:79], v[152:155], v[16:31]
    v_mfma_f32_32x32x16_bf16 v[32:47], v[72:75], v[156:159], v[32:47]
    v_mfma_f32_32x32x16_bf16 v[48:63], v[76:79], v[156:159], v[48:63]
    ds_read_b64_tr_b16 v[72:73], v253 offset:0
    ds_read_b64_tr_b16 v[74:75], v253 offset:1024
    ds_read_b64_tr_b16 v[76:77], v254 offset:0
    ds_read_b64_tr_b16 v[78:79], v254 offset:1024
    s_waitcnt lgkmcnt(4)
    v_mfma_f32_32x32x16_bf16 v[0:15], v[64:67], v[160:163], v[0:15]
    s_add_u32 m0, s58, 90112
    s_add_u32 s46, s59, 0
    buffer_load_dwordx4 v242, s[24:27], s46 offen lds
    s_add_u32 m0, s58, 91136
    s_add_u32 s46, s59, 7168
    buffer_load_dwordx4 v242, s[24:27], s46 offen lds
    v_mfma_f32_32x32x16_bf16 v[16:31], v[68:71], v[160:163], v[16:31]
    v_mfma_f32_32x32x16_bf16 v[32:47], v[64:67], v[164:167], v[32:47]
    v_mfma_f32_32x32x16_bf16 v[48:63], v[68:71], v[164:167], v[48:63]
    ds_read_b64_tr_b16 v[64:65], v253 offset:8192
    ds_read_b64_tr_b16 v[66:67], v253 offset:9216
    ds_read_b64_tr_b16 v[68:69], v254 offset:8192
    ds_read_b64_tr_b16 v[70:71], v254 offset:9216
    s_waitcnt lgkmcnt(4)
    v_mfma_f32_32x32x16_bf16 v[0:15], v[72:75], v[168:171], v[0:15]
    s_add_u32 m0, s58, 147456
    s_add_u32 s46, s59, 14336
    buffer_load_dwordx4 v242, s[24:27], s46 offen lds
    s_add_u32 m0, s58, 148480
    s_add_u32 s46, s59, 21504
    buffer_load_dwordx4 v242, s[24:27], s46 offen lds
    v_mfma_f32_32x32x16_bf16 v[16:31], v[76:79], v[168:171], v[16:31]
    v_mfma_f32_32x32x16_bf16 v[32:47], v[72:75], v[172:175], v[32:47]
    v_mfma_f32_32x32x16_bf16 v[48:63], v[76:79], v[172:175], v[48:63]
    ds_read_b64_tr_b16 v[72:73], v243 offset:57344
    ds_read_b64_tr_b16 v[74:75], v243 offset:58368
    ds_read_b64_tr_b16 v[76:77], v244 offset:57344
    ds_read_b64_tr_b16 v[78:79], v244 offset:58368
    s_waitcnt lgkmcnt(4)
    v_mfma_f32_32x32x16_bf16 v[0:15], v[64:67], v[176:179], v[0:15]
    s_add_u32 m0, s58, 155648
    s_add_u32 s46, s59, 28672
    buffer_load_dwordx4 v242, s[24:27], s46 offen lds
    s_add_u32 m0, s58, 156672
    s_add_u32 s46, s59, 35840
    buffer_load_dwordx4 v242, s[24:27], s46 offen lds
    v_mfma_f32_32x32x16_bf16 v[16:31], v[68:71], v[176:179], v[16:31]
    v_mfma_f32_32x32x16_bf16 v[32:47], v[64:67], v[180:183], v[32:47]
    v_mfma_f32_32x32x16_bf16 v[48:63], v[68:71], v[180:183], v[48:63]
    ds_read_b64_tr_b16 v[64:65], v243 offset:0
    ds_read_b64_tr_b16 v[66:67], v243 offset:1024
    ds_read_b64_tr_b16 v[68:69], v244 offset:0
    ds_read_b64_tr_b16 v[70:71], v244 offset:1024
    s_waitcnt lgkmcnt(4)
    v_mfma_f32_32x32x16_bf16 v[0:15], v[72:75], v[184:187], v[0:15]
    s_add_u32 m0, s58, 57344
    s_add_u32 s46, s59, 43008
    buffer_load_dwordx4 v242, s[24:27], s46 offen lds
    s_add_u32 m0, s58, 58368
    s_add_u32 s46, s59, 50176
    buffer_load_dwordx4 v242, s[24:27], s46 offen lds
    v_mfma_f32_32x32x16_bf16 v[16:31], v[76:79], v[184:187], v[16:31]
    v_mfma_f32_32x32x16_bf16 v[32:47], v[72:75], v[188:191], v[32:47]
    v_mfma_f32_32x32x16_bf16 v[48:63], v[76:79], v[188:191], v[48:63]
    ds_read_b64_tr_b16 v[72:73], v243 offset:8192
    ds_read_b64_tr_b16 v[74:75], v243 offset:9216
    ds_read_b64_tr_b16 v[76:77], v244 offset:8192
    ds_read_b64_tr_b16 v[78:79], v244 offset:9216
    s_waitcnt lgkmcnt(4)
    v_mfma_f32_32x32x16_bf16 v[0:15], v[64:67], v[192:195], v[0:15]
    s_add_u32 m0, s58, 0
    s_add_u32 s46, s60, 0
    buffer_load_dwordx4 v242, s[28:31], s46 offen lds
    s_add_u32 m0, s58, 1024
    s_add_u32 s46, s60, 7168
    buffer_load_dwordx4 v242, s[28:31], s46 offen lds
    v_mfma_f32_32x32x16_bf16 v[16:31], v[68:71], v[192:195], v[16:31]
    v_mfma_f32_32x32x16_bf16 v[32:47], v[64:67], v[196:199], v[32:47]
    v_mfma_f32_32x32x16_bf16 v[48:63], v[68:71], v[196:199], v[48:63]
    ds_read_b64_tr_b16 v[64:65], v243 offset:16384
    ds_read_b64_tr_b16 v[66:67], v243 offset:17408
    ds_read_b64_tr_b16 v[68:69], v244 offset:16384
    ds_read_b64_tr_b16 v[70:71], v244 offset:17408
    s_waitcnt lgkmcnt(4)
    v_mfma_f32_32x32x16_bf16 v[0:15], v[72:75], v[200:203], v[0:15]
    s_add_u32 m0, s58, 8192
    s_add_u32 s46, s60, 14336
    buffer_load_dwordx4 v242, s[28:31], s46 offen lds
    s_add_u32 m0, s58, 9216
    s_add_u32 s46, s60, 21504
    buffer_load_dwordx4 v242, s[28:31], s46 offen lds
    v_mfma_f32_32x32x16_bf16 v[16:31], v[76:79], v[200:203], v[16:31]
    v_mfma_f32_32x32x16_bf16 v[32:47], v[72:75], v[204:207], v[32:47]
    v_mfma_f32_32x32x16_bf16 v[48:63], v[76:79], v[204:207], v[48:63]
    ds_read_b64_tr_b16 v[72:73], v243 offset:24576
    ds_read_b64_tr_b16 v[74:75], v243 offset:25600
    ds_read_b64_tr_b16 v[76:77], v244 offset:24576
    ds_read_b64_tr_b16 v[78:79], v244 offset:25600
    s_waitcnt lgkmcnt(4)
    v_mfma_f32_32x32x16_bf16 v[0:15], v[64:67], v[208:211], v[0:15]
    s_add_u32 m0, s58, 16384
    s_add_u32 s46, s60, 25088
    buffer_load_dwordx4 v242, s[28:31], s46 offen lds
    s_add_u32 m0, s58, 17408
    s_add_u32 s46, s60, 32256
    buffer_load_dwordx4 v242, s[28:31], s46 offen lds
    v_mfma_f32_32x32x16_bf16 v[16:31], v[68:71], v[208:211], v[16:31]
    v_mfma_f32_32x32x16_bf16 v[32:47], v[64:67], v[212:215], v[32:47]
    v_mfma_f32_32x32x16_bf16 v[48:63], v[68:71], v[212:215], v[48:63]
    ds_read_b64_tr_b16 v[64:65], v243 offset:32768
    ds_read_b64_tr_b16 v[66:67], v243 offset:33792
    ds_read_b64_tr_b16 v[68:69], v244 offset:32768
    ds_read_b64_tr_b16 v[70:71], v244 offset:33792
    s_waitcnt lgkmcnt(4)
    v_mfma_f32_32x32x16_bf16 v[0:15], v[72:75], v[216:219], v[0:15]
    s_add_u32 m0, s58, 24576
    s_add_u32 s46, s60, 39424
    buffer_load_dwordx4 v242, s[28:31], s46 offen lds
    s_add_u32 m0, s58, 25600
    s_add_u32 s46, s60, 46592
    buffer_load_dwordx4 v242, s[28:31], s46 offen lds
    v_mfma_f32_32x32x16_bf16 v[16:31], v[76:79], v[216:219], v[16:31]
    v_mfma_f32_32x32x16_bf16 v[32:47], v[72:75], v[220:223], v[32:47]
    v_mfma_f32_32x32x16_bf16 v[48:63], v[76:79], v[220:223], v[48:63]
    ds_read_b64_tr_b16 v[72:73], v243 offset:40960
    ds_read_b64_tr_b16 v[74:75], v243 offset:41984
    ds_read_b64_tr_b16 v[76:77], v244 offset:40960
    ds_read_b64_tr_b16 v[78:79], v244 offset:41984
    s_waitcnt lgkmcnt(4)
    v_mfma_f32_32x32x16_bf16 v[0:15], v[64:67], v[224:227], v[0:15]
    s_add_u32 m0, s58, 32768
    s_add_u32 s46, s60, 50176
    buffer_load_dwordx4 v242, s[28:31], s46 offen lds
    s_add_u32 m0, s58, 33792
    s_add_u32 s46, s60, 57344
    buffer_load_dwordx4 v242, s[28:31], s46 offen lds
    v_mfma_f32_32x32x16_bf16 v[16:31], v[68:71], v[224:227], v[16:31]
    v_mfma_f32_32x32x16_bf16 v[32:47], v[64:67], v[228:231], v[32:47]
    v_mfma_f32_32x32x16_bf16 v[48:63], v[68:71], v[228:231], v[48:63]
    ds_read_b64_tr_b16 v[64:65], v243 offset:49152
    ds_read_b64_tr_b16 v[66:67], v243 offset:50176
    ds_read_b64_tr_b16 v[68:69], v244 offset:49152
    ds_read_b64_tr_b16 v[70:71], v244 offset:50176
    s_waitcnt lgkmcnt(4)
    v_mfma_f32_32x32x16_bf16 v[0:15], v[72:75], v[232:235], v[0:15]
    s_add_u32 m0, s58, 40960
    s_add_u32 s46, s60, 64512
    buffer_load_dwordx4 v242, s[28:31], s46 offen lds
    s_add_u32 m0, s58, 41984
    s_add_u32 s46, s60, 71680
    buffer_load_dwordx4 v242, s[28:31], s46 offen lds
    v_mfma_f32_32x32x16_bf16 v[16:31], v[76:79], v[232:235], v[16:31]
    v_mfma_f32_32x32x16_bf16 v[32:47], v[72:75], v[236:239], v[32:47]
    v_mfma_f32_32x32x16_bf16 v[48:63], v[76:79], v[236:239], v[48:63]
    s_waitcnt vmcnt(26)
    ds_read_b64_tr_b16 v[72:73], v240 offset:0
    ds_read_b64_tr_b16 v[74:75], v240 offset:1024
    ds_read_b64_tr_b16 v[76:77], v241 offset:0
    ds_read_b64_tr_b16 v[78:79], v241 offset:1024
    s_waitcnt lgkmcnt(4)
    v_mfma_f32_32x32x16_bf16 v[0:15], v[64:67], v[80:83], v[0:15]
    s_add_u32 m0, s58, 49152
    s_add_u32 s46, s60, 75264
    buffer_load_dwordx4 v242, s[28:31], s46 offen lds
    s_add_u32 m0, s58, 50176
    s_add_u32 s46, s60, 82432
    buffer_load_dwordx4 v242, s[28:31], s46 offen lds
    v_mfma_f32_32x32x16_bf16 v[16:31], v[68:71], v[80:83], v[16:31]
    v_mfma_f32_32x32x16_bf16 v[32:47], v[64:67], v[84:87], v[32:47]
    v_mfma_f32_32x32x16_bf16 v[48:63], v[68:71], v[84:87], v[48:63]
    s_waitcnt vmcnt(24)
    ds_read_b64_tr_b16 v[64:65], v240 offset:8192
    ds_read_b64_tr_b16 v[66:67], v240 offset:9216
    ds_read_b64_tr_b16 v[68:69], v241 offset:8192
    ds_read_b64_tr_b16 v[70:71], v241 offset:9216
    s_waitcnt lgkmcnt(4)
    v_mfma_f32_32x32x16_bf16 v[0:15], v[72:75], v[88:91], v[0:15]
    s_add_u32 m0, s58, 65536
    s_add_u32 s46, s60, 89600
    buffer_load_dwordx4 v242, s[28:31], s46 offen lds
    s_add_u32 m0, s58, 66560
    s_add_u32 s46, s60, 96768
    buffer_load_dwordx4 v242, s[28:31], s46 offen lds
    v_mfma_f32_32x32x16_bf16 v[16:31], v[76:79], v[88:91], v[16:31]
    v_mfma_f32_32x32x16_bf16 v[32:47], v[72:75], v[92:95], v[32:47]
    v_mfma_f32_32x32x16_bf16 v[48:63], v[76:79], v[92:95], v[48:63]
    s_waitcnt vmcnt(24)
    ds_read_b64_tr_b16 v[72:73], v240 offset:16384
    ds_read_b64_tr_b16 v[74:75], v240 offset:17408
    ds_read_b64_tr_b16 v[76:77], v241 offset:16384
    ds_read_b64_tr_b16 v[78:79], v241 offset:17408
    s_waitcnt lgkmcnt(4)
    v_mfma_f32_32x32x16_bf16 v[0:15], v[64:67], v[96:99], v[0:15]
    v_mfma_f32_32x32x16_bf16 v[16:31], v[68:71], v[96:99], v[16:31]
    v_mfma_f32_32x32x16_bf16 v[32:47], v[64:67], v[100:103], v[32:47]
    v_mfma_f32_32x32x16_bf16 v[48:63], v[68:71], v[100:103], v[48:63]
    s_waitcnt vmcnt(22)
    ds_read_b64_tr_b16 v[64:65], v240 offset:24576
    ds_read_b64_tr_b16 v[66:67], v240 offset:25600
    ds_read_b64_tr_b16 v[68:69], v241 offset:24576
    ds_read_b64_tr_b16 v[70:71], v241 offset:25600
    s_waitcnt lgkmcnt(4)
    v_mfma_f32_32x32x16_bf16 v[0:15], v[72:75], v[104:107], v[0:15]
    v_mfma_f32_32x32x16_bf16 v[16:31], v[76:79], v[104:107], v[16:31]
    v_mfma_f32_32x32x16_bf16 v[32:47], v[72:75], v[108:111], v[32:47]
    v_mfma_f32_32x32x16_bf16 v[48:63], v[76:79], v[108:111], v[48:63]
    s_waitcnt vmcnt(20)
    ds_read_b64_tr_b16 v[72:73], v253 offset:0
    ds_read_b64_tr_b16 v[74:75], v253 offset:1024
    ds_read_b64_tr_b16 v[76:77], v254 offset:0
    ds_read_b64_tr_b16 v[78:79], v254 offset:1024
    s_waitcnt lgkmcnt(4)
    v_mfma_f32_32x32x16_bf16 v[0:15], v[64:67], v[112:115], v[0:15]
    v_mfma_f32_32x32x16_bf16 v[16:31], v[68:71], v[112:115], v[16:31]
    v_mfma_f32_32x32x16_bf16 v[32:47], v[64:67], v[116:119], v[32:47]
    v_mfma_f32_32x32x16_bf16 v[48:63], v[68:71], v[116:119], v[48:63]
    s_waitcnt vmcnt(18)
    ds_read_b64_tr_b16 v[64:65], v253 offset:8192
    ds_read_b64_tr_b16 v[66:67], v253 offset:9216
    ds_read_b64_tr_b16 v[68:69], v254 offset:8192
    ds_read_b64_tr_b16 v[70:71], v254 offset:9216
    s_waitcnt lgkmcnt(4)
    v_mfma_f32_32x32x16_bf16 v[0:15], v[72:75], v[120:123], v[0:15]
    v_mfma_f32_32x32x16_bf16 v[16:31], v[76:79], v[120:123], v[16:31]
    v_mfma_f32_32x32x16_bf16 v[32:47], v[72:75], v[124:127], v[32:47]
    v_mfma_f32_32x32x16_bf16 v[48:63], v[76:79], v[124:127], v[48:63]
    s_mov_b32 s46, 200000
L_poll_5:
    buffer_load_dword v249, v246, s[20:23], s7 offen sc1
    s_waitcnt vmcnt(0)
    v_cmp_le_u32 vcc, 1, v249
    s_nop 1
    s_and_b64 s[44:45], vcc, s[92:93]
    s_cmp_eq_u64 s[44:45], s[92:93]
    s_cbranch_scc1 L_polld_6
    s_sleep 2
    s_sub_u32 s46, s46, 1
    s_cmp_lg_u32 s46, 0
    s_cbranch_scc1 L_poll_5
L_polld_6:
    ds_read_b64_tr_b16 v[72:73], v243 offset:57344
    ds_read_b64_tr_b16 v[74:75], v243 offset:58368
    ds_read_b64_tr_b16 v[76:77], v244 offset:57344
    ds_read_b64_tr_b16 v[78:79], v244 offset:58368
    s_waitcnt lgkmcnt(4)
    v_mfma_f32_32x32x16_bf16 v[0:15], v[64:67], v[128:131], v[0:15]
    buffer_load_dwordx4 v[144:147], v245, s[20:23], s88 offen offset:0 sc1
    v_mfma_f32_32x32x16_bf16 v[16:31], v[68:71], v[128:131], v[16:31]
    buffer_load_dwordx4 v[148:151], v245, s[20:23], s88 offen offset:1024 sc1
    v_mfma_f32_32x32x16_bf16 v[32:47], v[64:67], v[132:135], v[32:47]
    buffer_load_dwordx4 v[152:155], v245, s[20:23], s88 offen offset:2048 sc1
    v_mfma_f32_32x32x16_bf16 v[48:63], v[68:71], v[132:135], v[48:63]
    buffer_load_dwordx4 v[156:159], v245, s[20:23], s88 offen offset:3072 sc1
    s_waitcnt lgkmcnt(0)
    v_mfma_f32_32x32x16_bf16 v[0:15], v[72:75], v[136:139], v[0:15]
    buffer_load_dwordx4 v[160:163], v245, s[20:23], s80 offen offset:0 sc1
    v_mfma_f32_32x32x16_bf16 v[16:31], v[76:79], v[136:139], v[16:31]
    buffer_load_dwordx4 v[164:167], v245, s[20:23], s80 offen offset:1024 sc1
    v_mfma_f32_32x32x16_bf16 v[32:47], v[72:75], v[140:143], v[32:47]
    buffer_load_dwordx4 v[168:171], v245, s[20:23], s80 offen offset:2048 sc1
    v_mfma_f32_32x32x16_bf16 v[48:63], v[76:79], v[140:143], v[48:63]
    buffer_load_dwordx4 v[172:175], v245, s[20:23], s80 offen offset:3072 sc1
    v_add_u32 v82, s58, v245
    v_add_u32 v81, 65536, v82
    v_add_u32 v80, 147456, v82
    v_xor_b32 v84, 0x1000, v80
    v_xor_b32 v85, 0x800, v81
    v_xor_b32 v86, 0x1800, v81
    v_xor_b32 v87, 0x1800, v82
    s_lshl_b32 s46, s87, 11
    v_xor_b32 v243, s46, v243
    v_xor_b32 v244, s46, v244
    v_xor_b32 v240, s46, v240
    v_xor_b32 v241, s46, v241
    v_xor_b32 v120, 0x800, v243
    v_xor_b32 v121, 0x800, v244
    v_xor_b32 v122, 0x800, v240
    v_xor_b32 v123, 0x800, v241
    s_barrier
    ds_read_b64_tr_b16 v[88:89], v244 offset:0
    ds_read_b64_tr_b16 v[90:91], v244 offset:1024
    ds_read_b64_tr_b16 v[92:93], v244 offset:8192
    ds_read_b64_tr_b16 v[94:95], v244 offset:9216
    ds_read_b64_tr_b16 v[96:97], v244 offset:16384
    ds_read_b64_tr_b16 v[98:99], v244 offset:17408
    ds_read_b64_tr_b16 v[100:101], v244 offset:24576
    ds_read_b64_tr_b16 v[102:103], v244 offset:25600
    ds_read_b64_tr_b16 v[104:105], v244 offset:32768
    ds_read_b64_tr_b16 v[106:107], v244 offset:33792
    s_waitcnt lgkmcnt(8)
    s_waitcnt vmcnt(7)
    v_mfma_f32_32x32x16_bf16 v[16:31], v[88:91], v[144:147], v[16:31]
    buffer_load_dwordx4 v[176:179], v245, s[20:23], s89 offen offset:0 sc1
    ds_read_b64_tr_b16 v[108:109], v244 offset:40960
    ds_read_b64_tr_b16 v[110:111], v244 offset:41984
    ds_write_b128 v81, v[32:35] offset:8192
    s_waitcnt lgkmcnt(9)
    s_waitcnt vmcnt(7)
    v_mfma_f32_32x32x16_bf16 v[16:31], v[92:95], v[148:151], v[16:31]
    buffer_load_dwordx4 v[180:183], v245, s[20:23], s89 offen offset:1024 sc1
    ds_read_b64_tr_b16 v[88:89], v244 offset:49152
    ds_read_b64_tr_b16 v[90:91], v244 offset:50176
    s_waitcnt lgkmcnt(9)
    s_waitcnt vmcnt(7)
    v_mfma_f32_32x32x16_bf16 v[16:31], v[96:99], v[152:155], v[16:31]
    buffer_load_dwordx4 v[184:187], v245, s[20:23], s89 offen offset:2048 sc1
    ds_read_b64_tr_b16 v[92:93], v241 offset:0
    ds_read_b64_tr_b16 v[94:95], v241 offset:1024
    ds_write_b128 v81, v[36:39] offset:9216
    s_waitcnt lgkmcnt(10)
    s_waitcnt vmcnt(7)
    v_mfma_f32_32x32x16_bf16 v[16:31], v[100:103], v[156:159], v[16:31]
    buffer_load_dwordx4 v[188:191], v245, s[20:23], s89 offen offset:3072 sc1
    ds_read_b64_tr_b16 v[96:97], v121 offset:0
    ds_read_b64_tr_b16 v[98:99], v121 offset:1024
    s_waitcnt lgkmcnt(10)
    s_waitcnt vmcnt(7)
    v_mfma_f32_32x32x16_bf16 v[16:31], v[104:107], v[160:163], v[16:31]
    buffer_load_dwordx4 v[192:195], v245, s[20:23], s81 offen offset:0 sc1
    ds_read_b64_tr_b16 v[100:101], v121 offset:8192
    ds_read_b64_tr_b16 v[102:103], v121 offset:9216
    ds_write_b128 v81, v[40:43] offset:16384
    s_waitcnt lgkmcnt(11)
    s_waitcnt vmcnt(7)
    v_mfma_f32_32x32x16_bf16 v[16:31], v[108:111], v[164:167], v[16:31]
    buffer_load_dwordx4 v[196:199], v245, s[20:23], s81 offen offset:1024 sc1
    ds_read_b64_tr_b16 v[104:105], v121 offset:16384
    ds_read_b64_tr_b16 v[106:107], v121 offset:17408
    s_waitcnt lgkmcnt(10)
    s_waitcnt vmcnt(7)
    v_mfma_f32_32x32x16_bf16 v[16:31], v[88:91], v[168:171], v[16:31]
    buffer_load_dwordx4 v[200:203], v245, s[20:23], s81 offen offset:2048 sc1
    ds_read_b64_tr_b16 v[108:109], v121 offset:24576
    ds_read_b64_tr_b16 v[110:111], v121 offset:25600
    ds_write_b128 v81, v[44:47] offset:17408
    s_waitcnt lgkmcnt(11)
    s_waitcnt vmcnt(7)
    v_mfma_f32_32x32x16_bf16 v[16:31], v[92:95], v[172:175], v[16:31]
    buffer_load_dwordx4 v[204:207], v245, s[20:23], s81 offen offset:3072 sc1
    ds_read_b64_tr_b16 v[88:89], v121 offset:32768
    ds_read_b64_tr_b16 v[90:91], v121 offset:33792
    s_waitcnt lgkmcnt(10)
    s_waitcnt vmcnt(7)
    v_mfma_f32_32x32x16_bf16 v[16:31], v[96:99], v[176:179], v[16:31]
    ds_read_b64_tr_b16 v[92:93], v121 offset:40960
    ds_read_b64_tr_b16 v[94:95], v121 offset:41984
    ds_write_b128 v81, v[48:51] offset:24576
    s_waitcnt lgkmcnt(11)
    s_waitcnt vmcnt(6)
    v_mfma_f32_32x32x16_bf16 v[16:31], v[100:103], v[180:183], v[16:31]
    ds_read_b64_tr_b16 v[96:97], v121 offset:49152
    ds_read_b64_tr_b16 v[98:99], v121 offset:50176
    s_waitcnt lgkmcnt(10)
    s_waitcnt vmcnt(5)
    v_mfma_f32_32x32x16_bf16 v[16:31], v[104:107], v[184:187], v[16:31]
    ds_read_b64_tr_b16 v[100:101], v123 offset:0
    ds_read_b64_tr_b16 v[102:103], v123 offset:1024
    ds_write_b128 v81, v[52:55] offset:25600
    s_waitcnt lgkmcnt(11)
    s_waitcnt vmcnt(4)
    v_mfma_f32_32x32x16_bf16 v[16:31], v[108:111], v[188:191], v[16:31]
    ds_read_b64_tr_b16 v[104:105], v243 offset:0
    ds_read_b64_tr_b16 v[106:107], v243 offset:1024
    s_waitcnt lgkmcnt(10)
    s_waitcnt vmcnt(3)
    v_mfma_f32_32x32x16_bf16 v[16:31], v[88:91], v[192:195], v[16:31]
    ds_read_b64_tr_b16 v[108:109], v243 offset:8192
    ds_read_b64_tr_b16 v[110:111], v243 offset:9216
    ds_write_b128 v82, v[56:59] offset:57344
    s_waitcnt lgkmcnt(11)
    s_waitcnt vmcnt(2)
    v_mfma_f32_32x32x16_bf16 v[16:31], v[92:95], v[196:199], v[16:31]
    ds_read_b64_tr_b16 v[88:89], v243 offset:16384
    ds_read_b64_tr_b16 v[90:91], v243 offset:17408
    s_waitcnt lgkmcnt(10)
    s_waitcnt vmcnt(1)
    v_mfma_f32_32x32x16_bf16 v[16:31], v[96:99], v[200:203], v[16:31]
    ds_read_b64_tr_b16 v[92:93], v243 offset:24576
    ds_read_b64_tr_b16 v[94:95], v243 offset:25600
    ds_write_b128 v82, v[60:63] offset:58368
    s_waitcnt lgkmcnt(11)
    s_waitcnt vmcnt(0)
    v_mfma_f32_32x32x16_bf16 v[16:31], v[100:103], v[204:207], v[16:31]
    ds_read_b64_tr_b16 v[96:97], v243 offset:32768
    ds_read_b64_tr_b16 v[98:99], v243 offset:33792
    s_waitcnt lgkmcnt(10)
    v_mfma_f32_32x32x16_bf16 v[0:15], v[104:107], v[144:147], v[0:15]
    ds_read_b64_tr_b16 v[100:101], v243 offset:40960
    ds_read_b64_tr_b16 v[102:103], v243 offset:41984
    s_waitcnt lgkmcnt(10)
    v_mfma_f32_32x32x16_bf16 v[0:15], v[108:111], v[148:151], v[0:15]
    ds_read_b64_tr_b16 v[104:105], v243 offset:49152
    ds_read_b64_tr_b16 v[106:107], v243 offset:50176
    s_waitcnt lgkmcnt(9)
    v_mfma_f32_32x32x16_bf16 v[0:15], v[88:91], v[152:155], v[0:15]
    ds_read_b64_tr_b16 v[108:109], v240 offset:0
    ds_read_b64_tr_b16 v[110:111], v240 offset:1024
    ds_write_b128 v80, v[16:19] offset:0
    ds_write_b128 v80, v[20:23] offset:1024
    s_waitcnt lgkmcnt(11)
    v_mfma_f32_32x32x16_bf16 v[0:15], v[92:95], v[156:159], v[0:15]
    ds_read_b64_tr_b16 v[88:89], v120 offset:0
    ds_read_b64_tr_b16 v[90:91], v120 offset:1024
    ds_write_b128 v80, v[24:27] offset:8192
    ds_write_b128 v80, v[28:31] offset:9216
    s_waitcnt lgkmcnt(12)
    v_mfma_f32_32x32x16_bf16 v[0:15], v[96:99], v[160:163], v[0:15]
    ds_read_b64_tr_b16 v[92:93], v120 offset:8192
    ds_read_b64_tr_b16 v[94:95], v120 offset:9216
    s_waitcnt lgkmcnt(12)
    v_mfma_f32_32x32x16_bf16 v[0:15], v[100:103], v[164:167], v[0:15]
    ds_read_b64_tr_b16 v[96:97], v120 offset:16384
    ds_read_b64_tr_b16 v[98:99], v120 offset:17408
    s_waitcnt lgkmcnt(4)
    s_barrier
    ds_read_b128 v[32:35], v85 offset:8192
    ds_read_b128 v[36:39], v85 offset:9216
    ds_read_b128 v[40:43], v85 offset:16384
    v_mfma_f32_32x32x16_bf16 v[0:15], v[104:107], v[168:171], v[0:15]
    ds_read_b64_tr_b16 v[100:101], v120 offset:24576
    ds_read_b64_tr_b16 v[102:103], v120 offset:25600
    ds_read_b128 v[44:47], v85 offset:17408
    ds_read_b128 v[48:51], v86 offset:24576
    ds_read_b128 v[52:55], v86 offset:25600
    v_mfma_f32_32x32x16_bf16 v[0:15], v[108:111], v[172:175], v[0:15]
    ds_read_b64_tr_b16 v[104:105], v120 offset:32768
    ds_read_b64_tr_b16 v[106:107], v120 offset:33792
    ds_read_b128 v[56:59], v87 offset:57344
    ds_read_b128 v[60:63], v87 offset:58368
    ds_read_b128 v[16:19], v84 offset:0
    v_mfma_f32_32x32x16_bf16 v[0:15], v[88:91], v[176:179], v[0:15]
    ds_read_b64_tr_b16 v[108:109], v120 offset:40960
    ds_read_b64_tr_b16 v[110:111], v120 offset:41984
    ds_read_b128 v[20:23], v84 offset:1024
    ds_read_b128 v[24:27], v84 offset:8192
    ds_read_b128 v[28:31], v84 offset:9216
    s_waitcnt lgkmcnt(15)
    v_mfma_f32_32x32x16_bf16 v[0:15], v[92:95], v[180:183], v[0:15]
    ds_read_b64_tr_b16 v[88:89], v120 offset:49152
    ds_read_b64_tr_b16 v[90:91], v120 offset:50176
    v_mfma_f32_32x32x16_bf16 v[0:15], v[96:99], v[184:187], v[0:15]
    ds_read_b64_tr_b16 v[92:93], v122 offset:0
    ds_read_b64_tr_b16 v[94:95], v122 offset:1024
    s_waitcnt lgkmcnt(15)
    v_mfma_f32_32x32x16_bf16 v[0:15], v[100:103], v[188:191], v[0:15]
    s_waitcnt lgkmcnt(4)
    v_add_f32 v32, v32, v48
    v_add_f32 v33, v33, v49
    v_add_f32 v34, v34, v50
    v_add_f32 v35, v35, v51
    v_add_f32 v36, v36, v52
    v_add_f32 v37, v37, v53
    v_mfma_f32_32x32x16_bf16 v[0:15], v[104:107], v[192:195], v[0:15]
    v_add_f32 v38, v38, v54
    v_add_f32 v39, v39, v55
    v_add_f32 v40, v40, v56
    v_add_f32 v41, v41, v57
    v_add_f32 v42, v42, v58
    v_add_f32 v43, v43, v59
    v_mfma_f32_32x32x16_bf16 v[0:15], v[108:111], v[196:199], v[0:15]
    v_add_f32 v44, v44, v60
    v_add_f32 v45, v45, v61
    v_add_f32 v46, v46, v62
    v_add_f32 v47, v47, v63
    v_add_f32 v32, v32, v16
    v_add_f32 v33, v33, v17
    s_waitcnt lgkmcnt(2)
    v_mfma_f32_32x32x16_bf16 v[0:15], v[88:91], v[200:203], v[0:15]
    v_add_f32 v34, v34, v18
    v_add_f32 v35, v35, v19
    v_add_f32 v36, v36, v20
    v_add_f32 v37, v37, v21
    v_add_f32 v38, v38, v22
    v_add_f32 v39, v39, v23
    s_waitcnt lgkmcnt(0)
    v_mfma_f32_32x32x16_bf16 v[0:15], v[92:95], v[204:207], v[0:15]
    v_add_f32 v40, v40, v24
    v_add_f32 v41, v41, v25
    v_add_f32 v42, v42, v26
    v_add_f32 v43, v43, v27
    v_add_f32 v44, v44, v28
    v_add_f32 v45, v45, v29
    v_add_f32 v46, v46, v30
    v_add_f32 v47, v47, v31
    s_nop 3
    v_add_f32 v0, v0, v32
    v_add_f32 v1, v1, v33
    v_add_f32 v2, v2, v34
    v_add_f32 v3, v3, v35
    v_add_f32 v4, v4, v36
    v_add_f32 v5, v5, v37
    v_add_f32 v6, v6, v38
    v_add_f32 v7, v7, v39
    v_add_f32 v8, v8, v40
    v_add_f32 v9, v9, v41
    v_add_f32 v10, v10, v42
    v_add_f32 v11, v11, v43
    v_add_f32 v12, v12, v44
    v_add_f32 v13, v13, v45
    v_add_f32 v14, v14, v46
    v_add_f32 v15, v15, v47
    v_cvt_pk_bf16_f32 v0, v0, v1
    v_cvt_pk_bf16_f32 v1, v2, v3
    v_cvt_pk_bf16_f32 v2, v4, v5
    v_cvt_pk_bf16_f32 v3, v6, v7
    v_cvt_pk_bf16_f32 v4, v8, v9
    v_cvt_pk_bf16_f32 v5, v10, v11
    v_cvt_pk_bf16_f32 v6, v12, v13
    v_cvt_pk_bf16_f32 v7, v14, v15
    s_nop 1
    v_permlane32_swap_b32 v0, v2
    v_permlane32_swap_b32 v1, v3
    v_permlane32_swap_b32 v4, v6
    v_permlane32_swap_b32 v5, v7
    s_nop 1
    buffer_store_dwordx4 v[0:3], v248, s[32:35], s94 offen offset:0
    buffer_store_dwordx4 v[4:7], v248, s[32:35], s94 offen offset:32
    s_endpgm
L_BS:
    v_lshrrev_b32 v1, 2, v255
    v_mul_u32_u24 v241, 896, v1
    v_mul_u32_u24 v240, 56, v1
    v_and_b32 v1, 3, v255
    v_lshl_add_u32 v241, v1, 4, v241
    v_lshl_add_u32 v240, v1, 4, v240
    s_mul_i32 s50, s43, 896
    s_mul_i32 s46, s95, 3584
    s_add_u32 s50, s50, s46
    s_mul_i32 s52, s43, 14336
    s_mul_i32 s46, s41, 56
    s_add_u32 s52, s52, s46
    s_mul_i32 s46, s95, 57344
    s_add_u32 s52, s52, s46
    s_lshl_b32 s53, s43, 10
    s_add_u32 s53, s53, 98304
    s_mov_b32 s96, s95
    s_mov_b32 s97, s95
    v_mov_b32 v8, 0
    v_mov_b32 v9, 0
    v_mov_b32 v10, 0
    v_mov_b32 v11, 0
    v_lshlrev_b32 v1, 4, v255
    s_lshl_b32 s46, s40, 13
    s_lshl_b32 s47, s43, 10
    s_add_u32 s46, s46, s47
    s_lshr_b32 s47, s41, 3
    s_lshl_b32 s47, s47, 12
    s_add_u32 s46, s46, s47
    s_add_u32 s46, s46, 10485760
    buffer_store_dwordx4 v[8:11], v1, s[20:23], s46 offen sc1
    s_lshl_b32 s54, s40, 1
    s_lshr_b32 s46, s41, 3
    s_add_u32 s54, s54, s46
    s_lshl_b32 s54, s54, 2
    s_add_u32 s54, s54, s43
    s_waitcnt vmcnt(1)
    v_lshlrev_b32 v12, 4, v255
    s_mul_i32 s55, s54, 3136
    buffer_load_dwordx4 v[16:19], v12, s[12:15], s55 offen
    s_add_u32 s55, s55, 1024
    buffer_load_dwordx4 v[16:19], v12, s[12:15], s55 offen
    s_add_u32 s55, s55, 1024
    buffer_load_dwordx4 v[16:19], v12, s[12:15], s55 offen
    s_add_u32 s55, s55, 1024
    buffer_load_dwordx4 v[16:19], v12, s[12:15], s55 offen
    s_add_u32 s55, s55, 1024
    s_cmp_ge_u32 s54, 64
    s_cselect_b32 s56, s78, s76
    s_cselect_b32 s57, s79, s77
    s_mov_b32 s58, 1605632
    s_mov_b32 s59, 0x20000
    s_and_b32 s55, s54, 63
    s_mul_i32 s55, s55, 25088
    v_lshrrev_b32 v12, 3, v255
    v_lshlrev_b32 v12, 8, v12
    v_and_b32 v13, 7, v255
    v_lshl_add_u32 v12, v13, 4, v12
    v_add_u32 v12, 0, v12
    v_min_u32 v13, 1535, v12
    v_add_u32 v13, 2048, v13
    buffer_load_dwordx4 v[16:19], v12, s[56:59], s55 offen
    buffer_load_dwordx4 v[16:19], v13, s[56:59], s55 offen
    s_add_u32 s55, s55, 3584
    buffer_load_dwordx4 v[16:19], v12, s[56:59], s55 offen
    buffer_load_dwordx4 v[16:19], v13, s[56:59], s55 offen
    s_add_u32 s55, s55, 3584
    buffer_load_dwordx4 v[16:19], v12, s[56:59], s55 offen
    buffer_load_dwordx4 v[16:19], v13, s[56:59], s55 offen
    s_add_u32 s55, s55, 3584
    buffer_load_dwordx4 v[16:19], v12, s[56:59], s55 offen
    buffer_load_dwordx4 v[16:19], v13, s[56:59], s55 offen
    s_add_u32 s55, s55, 3584
    buffer_load_dwordx4 v[16:19], v12, s[56:59], s55 offen
    buffer_load_dwordx4 v[16:19], v13, s[56:59], s55 offen
    s_add_u32 s55, s55, 3584
    buffer_load_dwordx4 v[16:19], v12, s[56:59], s55 offen
    buffer_load_dwordx4 v[16:19], v13, s[56:59], s55 offen
    s_add_u32 s55, s55, 3584
    buffer_load_dwordx4 v[16:19], v12, s[56:59], s55 offen
    buffer_load_dwordx4 v[16:19], v13, s[56:59], s55 offen
    s_add_u32 s55, s55, 3584
    s_barrier
    s_add_u32 m0, s53, 16384
    s_nop 0
    buffer_load_dwordx4 v240, s[16:19], s50 offen lds
    s_add_u32 s96, s96, 1
    s_add_u32 s50, s50, 3584
    s_cmp_eq_u32 s96, 7
    s_cselect_b32 s96, 0, s96
    s_cselect_b32 s46, 25088, 0
    s_sub_u32 s50, s50, s46
    s_add_u32 m0, s53, 20480
    s_nop 0
    buffer_load_dwordx4 v240, s[16:19], s50 offen lds
    s_add_u32 s96, s96, 1
    s_add_u32 s50, s50, 3584
    s_cmp_eq_u32 s96, 7
    s_cselect_b32 s96, 0, s96
    s_cselect_b32 s46, 25088, 0
    s_sub_u32 s50, s50, s46
    s_add_u32 m0, s53, 24576
    s_nop 0
    buffer_load_dwordx4 v240, s[16:19], s50 offen lds
    s_add_u32 s96, s96, 1
    s_add_u32 s50, s50, 3584
    s_cmp_eq_u32 s96, 7
    s_cselect_b32 s96, 0, s96
    s_cselect_b32 s46, 25088, 0
    s_sub_u32 s50, s50, s46
    s_add_u32 m0, s53, 28672
    s_nop 0
    buffer_load_dwordx4 v240, s[16:19], s50 offen lds
    s_add_u32 s96, s96, 1
    s_add_u32 s50, s50, 3584
    s_cmp_eq_u32 s96, 7
    s_cselect_b32 s96, 0, s96
    s_cselect_b32 s46, 25088, 0
    s_sub_u32 s50, s50, s46
    s_add_u32 m0, s53, 32768
    s_nop 0
    buffer_load_dwordx4 v240, s[16:19], s50 offen lds
    s_add_u32 s96, s96, 1
    s_add_u32 s50, s50, 3584
    s_cmp_eq_u32 s96, 7
    s_cselect_b32 s96, 0, s96
    s_cselect_b32 s46, 25088, 0
    s_sub_u32 s50, s50, s46
    s_add_u32 m0, s53, 36864
    s_nop 0
    buffer_load_dwordx4 v240, s[16:19], s50 offen lds
    s_add_u32 s96, s96, 1
    s_add_u32 s50, s50, 3584
    s_cmp_eq_u32 s96, 7
    s_cselect_b32 s96, 0, s96
    s_cselect_b32 s46, 25088, 0
    s_sub_u32 s50, s50, s46
    s_add_u32 m0, s53, 40960
    s_nop 0
    buffer_load_dwordx4 v240, s[16:19], s50 offen lds
    s_add_u32 m0, s53, 45056
    s_nop 0
    buffer_load_dwordx4 v241, s[12:15], s52 offen lds
    s_add_u32 s97, s97, 1
    s_add_u32 s52, s52, 57344
    s_cmp_eq_u32 s97, 7
    s_cselect_b32 s97, 0, s97
    s_cselect_b32 s46, 401408, 0
    s_sub_u32 s52, s52, s46
    s_add_u32 m0, s53, 49152
    s_nop 0
    buffer_load_dwordx4 v241, s[12:15], s52 offen lds
    s_add_u32 s97, s97, 1
    s_add_u32 s52, s52, 57344
    s_cmp_eq_u32 s97, 7
    s_cselect_b32 s97, 0, s97
    s_cselect_b32 s46, 401408, 0
    s_sub_u32 s52, s52, s46
    s_add_u32 m0, s53, 53248
    s_nop 0
    buffer_load_dwordx4 v241, s[12:15], s52 offen lds
    s_add_u32 s97, s97, 1
    s_add_u32 s52, s52, 57344
    s_cmp_eq_u32 s97, 7
    s_cselect_b32 s97, 0, s97
    s_cselect_b32 s46, 401408, 0
    s_sub_u32 s52, s52, s46
    s_add_u32 m0, s53, 57344
    s_nop 0
    buffer_load_dwordx4 v241, s[12:15], s52 offen lds
    s_add_u32 s97, s97, 1
    s_add_u32 s52, s52, 57344
    s_cmp_eq_u32 s97, 7
    s_cselect_b32 s97, 0, s97
    s_cselect_b32 s46, 401408, 0
    s_sub_u32 s52, s52, s46
    s_add_u32 m0, s53, 61440
    s_nop 0
    buffer_load_dwordx4 v241, s[12:15], s52 offen lds
    s_add_u32 s97, s97, 1
    s_add_u32 s52, s52, 57344
    s_cmp_eq_u32 s97, 7
    s_cselect_b32 s97, 0, s97
    s_cselect_b32 s46, 401408, 0
    s_sub_u32 s52, s52, s46
    v_mov_b32 v8, -1
    v_mov_b32 v9, -1
    v_mov_b32 v10, -1
    v_mov_b32 v11, -1
    v_lshlrev_b32 v1, 4, v255
    s_lshl_b32 s47, s40, 17
    s_lshr_b32 s46, s41, 3
    s_lshl_b32 s46, s46, 16
    s_add_u32 s47, s47, s46
    s_lshl_b32 s46, s43, 14
    s_add_u32 s47, s47, s46
    s_add_u32 s47, s47, 8388608
    s_waitcnt vmcnt(5)
    s_barrier
    s_add_u32 m0, s53, 0
    s_nop 0
    buffer_load_dwordx4 v241, s[12:15], s52 offen lds
    s_add_u32 s97, s97, 1
    s_add_u32 s52, s52, 57344
    s_cmp_eq_u32 s97, 7
    s_cselect_b32 s97, 0, s97
    s_cselect_b32 s46, 401408, 0
    s_sub_u32 s52, s52, s46
    s_add_u32 m0, s53, 4096
    s_nop 0
    buffer_load_dwordx4 v241, s[12:15], s52 offen lds
    s_waitcnt vmcnt(0)
    s_barrier
    s_cmp_lg_u32 s43, 0
    s_cbranch_scc1 L_noarr
    v_mov_b32 v1, 0
    v_mov_b32 v2, 1
    s_mov_b64 exec, 1
    buffer_atomic_add v2, v1, s[36:39], 0 offen sc1
    s_mov_b64 exec, -1
L_noarr:
    s_cmp_lg_u32 s43, 0
    s_cbranch_scc1 L_nopoll
    s_mov_b64 s[54:55], 1
    s_mov_b64 exec, 1
    s_waitcnt vmcnt(0)
    s_mov_b32 s46, 200000
L_poll_7:
    buffer_load_dword v2, v1, s[36:39], 0 offen sc1
    s_waitcnt vmcnt(0)
    v_cmp_le_u32 vcc, 32, v2
    s_nop 1
    s_and_b64 s[44:45], vcc, s[54:55]
    s_cmp_eq_u64 s[44:45], s[54:55]
    s_cbranch_scc1 L_polld_8
    s_sleep 2
    s_sub_u32 s46, s46, 1
    s_cmp_lg_u32 s46, 0
    s_cbranch_scc1 L_poll_7
L_polld_8:
    s_mov_b64 exec, -1
L_nopoll:
    s_barrier
    s_endpgm
L_end:
    s_endpgm
.section .rodata,"a"
.p2align 6
.amdhsa_kernel parallel_sum__grouped_kv_mqa__glu_gated_geglu__prompt_kernel
  .amdhsa_next_free_vgpr 256
  .amdhsa_next_free_sgpr 102
  .amdhsa_accum_offset 256
  .amdhsa_group_segment_fixed_size 0
  .amdhsa_kernarg_size 96
  .amdhsa_user_sgpr_count 2
  .amdhsa_user_sgpr_kernarg_segment_ptr 1
  .amdhsa_system_sgpr_workgroup_id_x 1
.end_amdhsa_kernel
```
